```python
import torch

def _softmax(x, axis=-1):
    return torch.softmax(x, dim=axis)
def _gelu(x):
    return torch.nn.functional.gelu(x, approximate="tanh")
def _silu(x):
    return torch.nn.functional.silu(x)
def _sigmoid(x):
    return torch.sigmoid(x)
def _layernorm(x, axis=-1, eps=1e-5):
    m = x.mean(dim=axis, keepdim=True)
    v = x.var(dim=axis, keepdim=True, unbiased=False)
    return (x - m) / torch.sqrt(v + eps)
def _scatter_add(tgt, idx, src, axis=0):
    return tgt.clone().index_add_(axis, idx, src)
def _segment_sum(src, seg, n):
    out = torch.zeros((n,) + src.shape[1:], dtype=src.dtype)
    return out.index_add_(0, seg, src)
def _pad(x, pw):
    flat = tuple(v for pair in reversed(pw) for v in pair)
    return torch.nn.functional.pad(x, flat)

kernel_name = 'sequential_preLN__linear_attn_block__glu_gated_glu__prompt'

def setup_inputs():

    _w = (lambda a: (lambda t: t.to(torch.bfloat16) if t.is_floating_point() else t)(torch.as_tensor(a)))
    def _A_setup():
        B, S, D = 1, 2048, 448
        return {
            "x": _w((lambda *s: torch.randn(*s, dtype=torch.bfloat16) * 0.05)(B, S, D)),
            "wqkv": _w((lambda *s: torch.randn(*s, dtype=torch.bfloat16) * 0.1)(D, 3 * D)),
            "wo": _w((lambda *s: torch.randn(*s, dtype=torch.bfloat16) * 0.05)(D, D)),
        }
    _A_in = _A_setup()

    def _B_setup():
        B, S, D, F = 1, 2048, 448, 1792
        return {
            "x": _w((lambda *s: torch.randn(*s, dtype=torch.bfloat16) * 0.05)(B, S, D)),
            "w_gate": _w((lambda *s: torch.randn(*s, dtype=torch.bfloat16) * 0.05)(D, F)),
            "w_up": _w((lambda *s: torch.randn(*s, dtype=torch.bfloat16) * 0.05)(D, F)),
            "w_down": _w((lambda *s: torch.randn(*s, dtype=torch.bfloat16) * 0.05)(F, D)),
        }
    _B_in = _B_setup()

    return {
        "A_x": _A_in["x"],
        "A_wqkv": _A_in["wqkv"],
        "A_wo": _A_in["wo"],
        "B_x": _B_in["x"],
        "B_w_gate": _B_in["w_gate"],
        "B_w_up": _B_in["w_up"],
        "B_w_down": _B_in["w_down"],
    }

def reference(A_x, A_wqkv, A_wo, B_x, B_w_gate, B_w_up, B_w_down):
    def _A_ref(x, wqkv, wo):
        B, S, D = x.shape
        H = 16; Dh = D // H
        qkv = (lambda x, *d: x.permute(*d))((x @ wqkv).reshape(B, S, 3, H, Dh), 2, 0, 3, 1, 4)
        q, k, v = qkv[0], qkv[1], qkv[2]
        phi = lambda t: torch.where(t > 0, t + 1, torch.exp(t)) + 1e-6
        pq, pk = phi(q), phi(k)
        kv = torch.einsum("bhsd,bhse->bhde", pk, v)
        z = torch.einsum("bhsd->bhd", pk)
        num = torch.einsum("bhqd,bhde->bhqe", pq, kv)
        den = torch.einsum("bhqd,bhd->bhq", pq, z)[..., None] + 1e-6
        o = num / den
        return (lambda x, *d: x.permute(*d))(o, 0, 2, 1, 3).reshape(B, S, D) @ wo

    def _B_ref(x, w_gate, w_up, w_down):
        g = torch.einsum("bsd,df->bsf", x, w_gate)
        u = torch.einsum("bsd,df->bsf", x, w_up)
        h = _sigmoid(g) * u
        return torch.einsum("bsf,fd->bsd", h, w_down)

    x = A_x
    h = x + _A_ref(_layernorm(x, axis=-1), A_wqkv, A_wo)
    h2 = h + _B_ref(_layernorm(h, axis=-1), B_w_gate, B_w_up, B_w_down)
    return h2
```

```asm
; @launch grid=(256,1,1) block=(256,1,1) lds=163840
.amdgcn_target "amdgcn-amd-amdhsa--gfx950"
.text
.globl sequential_preLN__linear_attn_block__glu_gated_glu__prompt_kernel
.p2align 8
.type sequential_preLN__linear_attn_block__glu_gated_glu__prompt_kernel,@function
sequential_preLN__linear_attn_block__glu_gated_glu__prompt_kernel:
    s_cmp_ge_u32 s2, 256
    s_cbranch_scc1 Lend
    s_load_dwordx2 s[8:9], s[0:1], 0
    s_load_dwordx2 s[12:13], s[0:1], 8
    s_load_dwordx2 s[36:37], s[0:1], 72
    s_load_dwordx2 s[16:17], s[0:1], 16
    v_lshrrev_b32 v1, 6, v0
    v_and_b32 v0, 63, v0
    s_lshr_b32 s79, s2, 3
    s_getpc_b64 s[4:5]
Lpc:
    v_lshl_add_u32 v3, s79, 2, v1
    v_mad_u32_u24 v3, v3, 3, v0
    v_lshlrev_b32 v3, 7, v3
    s_mov_b32 s6, Lcode_end-Lpc
    s_mov_b32 s7, 0x20000
    s_mov_b64 exec, 7
    buffer_load_dword v9, v3, s[4:7], 0 offen
    s_mov_b64 exec, -1
    s_and_b32 s46, s2, 7
    s_and_b32 s87, s79, 3
    s_lshr_b32 s44, s79, 2
    s_lshl2_add_u32 s43, s46, s87
    s_add_u32 s87, s87, s44
    s_lshl1_add_u32 s87, s87, s46
    s_mul_i32 s47, s87, 37
    s_lshr_b32 s47, s47, 8
    s_mul_i32 s47, s47, 7
    s_sub_u32 s87, s87, s47
    s_mul_i32 s47, s43, 57344
    s_lshl_b32 s87, s87, 7
    s_add_u32 s50, s87, s47
    s_add_u32 s88, s47, 896
    s_and_b32 s89, s44, 1
    v_lshrrev_b32 v4, 3, v0
    v_lshl_add_u32 v4, v1, 4, v4
    v_lshl_add_u32 v4, s89, 3, v4
    v_mul_u32_u24 v6, 896, v4
    v_and_b32 v5, 7, v0
    v_lshl_add_u32 v10, v5, 4, v6
    v_readfirstlane_b32 s42, v1
    s_mov_b32 s10, 0x1c0000
    s_mov_b32 s11, 0x20000
    s_waitcnt lgkmcnt(0)
    buffer_load_dwordx4 v[16:19], v10, s[8:11], s50 offen
    s_add_u32 s51, s50, 128
    s_cmp_eq_u32 s51, s88
    s_cselect_b32 s51, s47, s51
    buffer_load_dwordx4 v[20:23], v10, s[8:11], s51 offen
    s_add_u32 s52, s51, 128
    s_cmp_eq_u32 s52, s88
    s_cselect_b32 s52, s47, s52
    buffer_load_dwordx4 v[24:27], v10, s[8:11], s52 offen
    s_add_u32 s53, s52, 128
    s_cmp_eq_u32 s53, s88
    s_cselect_b32 s53, s47, s53
    buffer_load_dwordx4 v[28:31], v10, s[8:11], s53 offen
    s_add_u32 s54, s53, 128
    s_cmp_eq_u32 s54, s88
    s_cselect_b32 s54, s47, s54
    buffer_load_dwordx4 v[32:35], v10, s[8:11], s54 offen
    s_add_u32 s55, s54, 128
    s_cmp_eq_u32 s55, s88
    s_cselect_b32 s55, s47, s55
    buffer_load_dwordx4 v[36:39], v10, s[8:11], s55 offen
    s_add_u32 s56, s55, 128
    s_cmp_eq_u32 s56, s88
    s_cselect_b32 s56, s47, s56
    buffer_load_dwordx4 v[40:43], v10, s[8:11], s56 offen
    s_load_dwordx2 s[20:21], s[0:1], 32
    s_load_dwordx2 s[24:25], s[0:1], 40
    s_load_dwordx2 s[28:29], s[0:1], 48
    s_load_dwordx2 s[32:33], s[0:1], 56
    s_load_dwordx2 s[40:41], s[0:1], 64
    s_mul_i32 s89, s89, -14336
    s_add_u32 s89, s89, 7168
    v_add_u32 v11, s89, v10
    v_lshlrev_b32 v2, 4, v0
    v_add_u32 v3, s89, v6
    s_sub_u32 s60, s50, s47
    s_mul_i32 s60, s60, 1344
    s_sub_u32 s61, s51, s47
    s_mul_i32 s61, s61, 1344
    s_sub_u32 s62, s52, s47
    s_mul_i32 s62, s62, 1344
    s_sub_u32 s63, s53, s47
    s_mul_i32 s63, s63, 1344
    s_sub_u32 s64, s54, s47
    s_mul_i32 s64, s64, 1344
    s_sub_u32 s65, s55, s47
    s_mul_i32 s65, s65, 1344
    s_sub_u32 s66, s56, s47
    s_mul_i32 s66, s66, 1344
    s_mov_b32 s14, 0x126000
    s_mov_b32 s15, 0x20000
    s_mov_b32 s38, 0x10000000
    s_mov_b32 s39, 0x20000
    v_lshrrev_b32 v5, 1, v4
    v_xor_b32 v5, v5, v0
    v_and_b32 v5, 7, v5
    v_lshl_add_u32 v12, v5, 4, v6
    v_xor_b32 v5, 4, v5
    v_lshl_add_u32 v13, v5, 4, v3
    s_mov_b32 s67, s66
    s_mul_i32 s49, s44, 112
    s_add_u32 s49, s49, 896
    v_mov_b32 v7, 784
    s_lshl_b32 s57, s42, 10
    v_lshl_add_u32 v89, v1, 6, v0
    s_movk_i32 s90, 768
    s_cmp_ge_u32 s42, 2
    s_cselect_b32 s88, 0xffffff80, s90
    v_add_u32 v4, 0, v89
    v_mul_u32_u24 v5, 4682, v4
    v_lshrrev_b32 v5, 16, v5
    v_mul_u32_u24 v6, 14, v5
    v_sub_u32 v6, v4, v6
    v_cmp_le_u32 vcc, 7, v6
    v_bfe_u32 v4, v5, 1, 2
    v_and_b32 v3, 1, v5
    v_lshl_add_u32 v4, v3, 2, v4
    v_and_or_b32 v5, v5, 56, v4
    v_mul_u32_u24 v5, 2688, v5
    v_lshl_add_u32 v5, v6, 4, v5
    v_cndmask_b32 v4, 0, v7, vcc
    v_add3_u32 v72, v5, v4, s49
    s_waitcnt lgkmcnt(0)
    buffer_load_dwordx4 v[44:47], v11, s[8:11], s50 offen
    buffer_load_dwordx4 v[48:51], v11, s[8:11], s51 offen
    buffer_load_dwordx4 v[52:55], v11, s[8:11], s52 offen
    buffer_load_dwordx4 v[56:59], v11, s[8:11], s53 offen
    v_add_u32 v4, 256, v89
    v_mul_u32_u24 v5, 4682, v4
    v_lshrrev_b32 v5, 16, v5
    v_mul_u32_u24 v6, 14, v5
    v_sub_u32 v6, v4, v6
    v_cmp_le_u32 vcc, 7, v6
    v_bfe_u32 v4, v5, 1, 2
    v_and_b32 v3, 1, v5
    v_lshl_add_u32 v4, v3, 2, v4
    v_and_or_b32 v5, v5, 56, v4
    v_mul_u32_u24 v5, 2688, v5
    v_lshl_add_u32 v5, v6, 4, v5
    v_cndmask_b32 v4, 0, v7, vcc
    v_add3_u32 v73, v5, v4, s49
    v_add_u32 v4, 512, v89
    v_mul_u32_u24 v5, 4682, v4
    v_lshrrev_b32 v5, 16, v5
    v_mul_u32_u24 v6, 14, v5
    v_sub_u32 v6, v4, v6
    v_cmp_le_u32 vcc, 7, v6
    v_bfe_u32 v4, v5, 1, 2
    v_and_b32 v3, 1, v5
    v_lshl_add_u32 v4, v3, 2, v4
    v_and_or_b32 v5, v5, 56, v4
    v_mul_u32_u24 v5, 2688, v5
    v_lshl_add_u32 v5, v6, 4, v5
    v_cndmask_b32 v4, 0, v7, vcc
    v_add3_u32 v74, v5, v4, s49
    v_add_u32 v4, s88, v89
    v_mul_u32_u24 v5, 4682, v4
    v_lshrrev_b32 v5, 16, v5
    v_mul_u32_u24 v6, 14, v5
    v_sub_u32 v6, v4, v6
    v_cmp_le_u32 vcc, 7, v6
    v_bfe_u32 v4, v5, 1, 2
    v_and_b32 v3, 1, v5
    v_lshl_add_u32 v4, v3, 2, v4
    v_and_or_b32 v5, v5, 56, v4
    v_mul_u32_u24 v5, 2688, v5
    v_lshl_add_u32 v5, v6, 4, v5
    v_cndmask_b32 v4, 0, v7, vcc
    v_add3_u32 v75, v5, v4, s49
    v_add_u32 v4, 128, v89
    v_mul_u32_u24 v5, 4682, v4
    v_lshrrev_b32 v5, 16, v5
    v_mul_u32_u24 v6, 14, v5
    v_sub_u32 v6, v4, v6
    v_cmp_le_u32 vcc, 7, v6
    v_bfe_u32 v4, v5, 1, 2
    v_and_b32 v3, 1, v5
    v_lshl_add_u32 v4, v3, 2, v4
    v_and_or_b32 v5, v5, 56, v4
    v_mul_u32_u24 v5, 2688, v5
    v_lshl_add_u32 v5, v6, 4, v5
    v_cndmask_b32 v4, 0, v7, vcc
    v_add3_u32 v76, v5, v4, s49
    v_add_u32 v4, 384, v89
    v_mul_u32_u24 v5, 4682, v4
    v_lshrrev_b32 v5, 16, v5
    v_mul_u32_u24 v6, 14, v5
    v_sub_u32 v6, v4, v6
    v_cmp_le_u32 vcc, 7, v6
    v_bfe_u32 v4, v5, 1, 2
    v_and_b32 v3, 1, v5
    v_lshl_add_u32 v4, v3, 2, v4
    v_and_or_b32 v5, v5, 56, v4
    v_mul_u32_u24 v5, 2688, v5
    v_lshl_add_u32 v5, v6, 4, v5
    v_cndmask_b32 v4, 0, v7, vcc
    v_add3_u32 v77, v5, v4, s49
    v_add_u32 v4, 640, v89
    v_mul_u32_u24 v5, 4682, v4
    v_lshrrev_b32 v5, 16, v5
    v_mul_u32_u24 v6, 14, v5
    v_sub_u32 v6, v4, v6
    v_cmp_le_u32 vcc, 7, v6
    v_bfe_u32 v4, v5, 1, 2
    v_and_b32 v3, 1, v5
    v_lshl_add_u32 v4, v3, 2, v4
    v_and_or_b32 v5, v5, 56, v4
    v_mul_u32_u24 v5, 2688, v5
    v_lshl_add_u32 v5, v6, 4, v5
    v_cndmask_b32 v4, 0, v7, vcc
    v_add3_u32 v78, v5, v4, s49
    s_lshr_b32 s87, s42, 1
    s_lshl1_add_u32 s58, s43, s87
    s_and_b32 s76, s42, 1
    v_lshrrev_b32 v5, 3, v0
    v_lshlrev_b32 v5, 12, v5
    v_and_b32 v4, 7, v0
    v_lshl_add_u32 v79, v4, 4, v5
    s_lshl1_add_u32 s96, s44, s76
    s_lshl1_add_u32 s96, s96, s87
    s_lshl_b32 s96, s96, 8
    s_add_u32 s96, s96, s43
    s_lshl_b32 s96, s96, 7
    s_add_u32 s96, s96, 4194304
    v_mov_b32 v216, -1
    v_mov_b32 v217, -1
    v_mov_b32 v218, -1
    v_mov_b32 v219, -1
    s_lshl_b32 s97, s44, 5
    s_add_u32 s97, s97, s43
    s_lshl_b32 s97, s97, 7
    s_add_u32 s97, s97, 8388608
    s_lshl_b32 s89, s43, 10
    s_add_u32 s89, s89, 8912896
    s_lshl_b32 s87, s42, 7
    s_add_u32 s90, s89, s87
    s_sub_u32 s89, s89, 256
    s_cmp_eq_u32 s44, 0
    s_cselect_b32 s90, s90, 268435456
    s_cselect_b32 s89, s89, 268435456
    s_lshl_b32 s87, s2, 7
    s_add_u32 s87, s87, 8945408
    s_cmp_lt_u32 s2, 4
    s_cselect_b32 s87, s87, 268435456
    s_cmp_eq_u32 s42, 1
    s_cselect_b32 s87, s87, 268435456
    s_cmp_eq_u32 s42, 0
    s_cselect_b32 s89, s89, s87
    s_cselect_b32 s87, s97, 268435456
    v_mov_b32 v191, s89
    v_mov_b32 v220, 0
    s_mov_b64 exec, 0xffff
    v_mov_b32 v191, s90
    s_mov_b64 exec, 0xff
    v_mov_b32 v191, s87
    v_mov_b32 v220, -1
    s_mov_b64 exec, -1
    v_add_u32 v191, v191, v2
    v_mov_b32 v221, v220
    v_mov_b32 v222, v220
    v_mov_b32 v223, v220
    s_lshr_b32 s87, s42, 1
    s_lshl_b32 s87, s87, 5
    v_and_b32 v4, 31, v0
    v_add_u32 v4, s87, v4
    v_lshrrev_b32 v5, 1, v4
    v_and_b32 v5, 7, v5
    v_lshrrev_b32 v6, 5, v0
    v_mul_u32_u24 v4, 896, v4
    v_add_u32 v7, 0, v6
    v_xor_b32 v7, v7, v5
    v_lshl_add_u32 v88, v7, 4, v4
    v_add_u32 v7, 2, v6
    v_xor_b32 v7, v7, v5
    v_lshl_add_u32 v89, v7, 4, v4
    v_add_u32 v7, 4, v6
    v_xor_b32 v7, v7, v5
    v_lshl_add_u32 v90, v7, 4, v4
    v_add_u32 v7, 6, v6
    v_xor_b32 v7, v7, v5
    v_lshl_add_u32 v91, v7, 4, v4
    s_mul_i32 s87, s76, 48
    s_add_u32 s87, s87, 57344
    v_bfe_u32 v4, v0, 2, 2
    v_lshl_add_u32 v5, v6, 2, v4
    v_lshl_add_u32 v4, v6, 3, v4
    v_mul_u32_u24 v5, 448, v5
    v_bfe_u32 v7, v0, 4, 1
    v_lshl_add_u32 v5, v7, 5, v5
    v_and_b32 v3, 3, v0
    v_lshl_add_u32 v5, v3, 3, v5
    v_add_u32 v92, s87, v5
    v_add_u32 v93, 57344, v92
    v_lshlrev_b32 v5, 1, v7
    v_bfe_u32 v3, v0, 1, 1
    v_add_u32 v5, v5, v3
    v_bfe_u32 v3, v0, 3, 1
    v_xor_b32 v3, s76, v3
    v_lshl_add_u32 v5, v3, 2, v5
    v_lshlrev_b32 v5, 4, v5
    v_and_b32 v3, 1, v0
    v_lshl_add_u32 v5, v3, 3, v5
    v_lshl_add_u32 v94, v4, 7, v5
    v_lshrrev_b32 v4, 3, v0
    v_lshlrev_b32 v5, 2, v7
    v_xor_b32 v5, v5, v0
    v_and_b32 v5, 7, v5
    v_lshlrev_b32 v5, 4, v5
    v_mul_u32_u24 v3, 896, v4
    v_add_u32 v14, v3, v5
    v_lshl_add_u32 v4, v1, 3, v4
    v_mul_u32_u24 v4, 2688, v4
    s_lshl_b32 s87, s44, 7
    v_add3_u32 v95, v4, v5, s87
    s_mov_b32 s68, 0x3f803f80
    s_mov_b32 s69, 0xffff0000
    s_mov_b32 s70, 0x3b124925
    s_mov_b32 s71, 0x3fb8aa3b
    s_mov_b32 s91, 0x00003f80
    s_mov_b32 s92, 0x3f800000
    buffer_load_dwordx4 v[60:63], v11, s[8:11], s54 offen
    buffer_load_dwordx4 v[64:67], v11, s[8:11], s55 offen
    buffer_load_dwordx4 v[68:71], v11, s[8:11], s56 offen
    s_add_u32 m0, s57, 57344
    s_nop 0
    buffer_load_dwordx4 v72, s[12:15], s60 offen  lds
    s_add_u32 m0, s57, 61440
    s_nop 0
    buffer_load_dwordx4 v73, s[12:15], s60 offen  lds
    s_add_u32 m0, s57, 65536
    s_nop 0
    buffer_load_dwordx4 v74, s[12:15], s60 offen  lds
    s_cmp_ge_u32 s42, 2
    s_cselect_b32 s47, s61, s60
    s_add_u32 m0, s57, 69632
    s_nop 0
    buffer_load_dwordx4 v75, s[12:15], s47 offen  lds
    s_lshl_b32 s87, s2, 2
    s_add_u32 s87, s87, s42
    s_min_u32 s87, s87, 783
    s_mul_i32 s87, s87, 512
    s_load_dword s45, s[16:17], s87 offset:0
    s_load_dword s45, s[16:17], s87 offset:128
    s_load_dword s45, s[16:17], s87 offset:256
    s_load_dword s45, s[16:17], s87 offset:384
    v_mov_b32 v4, 0
    v_mov_b32 v5, 0
    v_mov_b32 v6, 0
    v_mov_b32 v7, 0
    s_waitcnt vmcnt(17)
    v_dot2c_f32_bf16 v4, s68, v16
    v_dot2c_f32_bf16 v5, v16, v16
    v_dot2c_f32_bf16 v6, s68, v17
    v_dot2c_f32_bf16 v7, v17, v17
    v_dot2c_f32_bf16 v4, s68, v18
    v_dot2c_f32_bf16 v5, v18, v18
    v_dot2c_f32_bf16 v6, s68, v19
    v_dot2c_f32_bf16 v7, v19, v19
    s_waitcnt vmcnt(16)
    v_dot2c_f32_bf16 v4, s68, v20
    v_dot2c_f32_bf16 v5, v20, v20
    v_dot2c_f32_bf16 v6, s68, v21
    v_dot2c_f32_bf16 v7, v21, v21
    v_dot2c_f32_bf16 v4, s68, v22
    v_dot2c_f32_bf16 v5, v22, v22
    v_dot2c_f32_bf16 v6, s68, v23
    v_dot2c_f32_bf16 v7, v23, v23
    s_waitcnt vmcnt(15)
    v_dot2c_f32_bf16 v4, s68, v24
    v_dot2c_f32_bf16 v5, v24, v24
    v_dot2c_f32_bf16 v6, s68, v25
    v_dot2c_f32_bf16 v7, v25, v25
    v_dot2c_f32_bf16 v4, s68, v26
    v_dot2c_f32_bf16 v5, v26, v26
    v_dot2c_f32_bf16 v6, s68, v27
    v_dot2c_f32_bf16 v7, v27, v27
    s_waitcnt vmcnt(14)
    v_dot2c_f32_bf16 v4, s68, v28
    v_dot2c_f32_bf16 v5, v28, v28
    v_dot2c_f32_bf16 v6, s68, v29
    v_dot2c_f32_bf16 v7, v29, v29
    v_dot2c_f32_bf16 v4, s68, v30
    v_dot2c_f32_bf16 v5, v30, v30
    v_dot2c_f32_bf16 v6, s68, v31
    v_dot2c_f32_bf16 v7, v31, v31
    s_waitcnt vmcnt(13)
    v_dot2c_f32_bf16 v4, s68, v32
    v_dot2c_f32_bf16 v5, v32, v32
    v_dot2c_f32_bf16 v6, s68, v33
    v_dot2c_f32_bf16 v7, v33, v33
    v_dot2c_f32_bf16 v4, s68, v34
    v_dot2c_f32_bf16 v5, v34, v34
    v_dot2c_f32_bf16 v6, s68, v35
    v_dot2c_f32_bf16 v7, v35, v35
    s_waitcnt vmcnt(12)
    v_dot2c_f32_bf16 v4, s68, v36
    v_dot2c_f32_bf16 v5, v36, v36
    v_dot2c_f32_bf16 v6, s68, v37
    v_dot2c_f32_bf16 v7, v37, v37
    v_dot2c_f32_bf16 v4, s68, v38
    v_dot2c_f32_bf16 v5, v38, v38
    v_dot2c_f32_bf16 v6, s68, v39
    v_dot2c_f32_bf16 v7, v39, v39
    s_waitcnt vmcnt(11)
    v_dot2c_f32_bf16 v4, s68, v40
    v_dot2c_f32_bf16 v5, v40, v40
    v_dot2c_f32_bf16 v6, s68, v41
    v_dot2c_f32_bf16 v7, v41, v41
    v_dot2c_f32_bf16 v4, s68, v42
    v_dot2c_f32_bf16 v5, v42, v42
    v_dot2c_f32_bf16 v6, s68, v43
    v_dot2c_f32_bf16 v7, v43, v43
    s_nop 1
    v_add_f32 v4, v4, v6
    v_add_f32 v5, v5, v7
    s_nop 0
    v_add_f32_dpp v4, v4, v4 quad_perm:[1,0,3,2] row_mask:0xf bank_mask:0xf
    v_add_f32_dpp v5, v5, v5 quad_perm:[1,0,3,2] row_mask:0xf bank_mask:0xf
    s_nop 0
    v_add_f32_dpp v4, v4, v4 quad_perm:[2,3,0,1] row_mask:0xf bank_mask:0xf
    v_add_f32_dpp v5, v5, v5 quad_perm:[2,3,0,1] row_mask:0xf bank_mask:0xf
    s_nop 0
    v_add_f32_dpp v4, v4, v4 row_half_mirror row_mask:0xf bank_mask:0xf
    v_add_f32_dpp v5, v5, v5 row_half_mirror row_mask:0xf bank_mask:0xf
    v_mul_f32 v4, 0xbb124925, v4
    v_mul_f32 v6, v4, v4
    v_fma_f32 v5, v5, s70, -v6
    v_add_f32 v5, 0x3727c5ac, v5
    v_rsq_f32 v6, v5
    s_nop 0
    v_mul_f32 v7, v4, v6
    v_lshlrev_b32 v80, 16, v16
    v_and_b32 v81, s69, v16
    v_lshlrev_b32 v82, 16, v17
    s_add_u32 m0, s57, 73728
    s_nop 0
    buffer_load_dwordx4 v76, s[12:15], s61 offen  lds
    v_and_b32 v83, s69, v17
    v_lshlrev_b32 v84, 16, v18
    v_and_b32 v85, s69, v18
    v_lshlrev_b32 v86, 16, v19
    v_and_b32 v87, s69, v19
    v_pk_fma_f32 v[80:81], v[80:81], v[6:7], v[6:7] op_sel:[0,0,1] op_sel_hi:[1,0,1]
    v_pk_fma_f32 v[82:83], v[82:83], v[6:7], v[6:7] op_sel:[0,0,1] op_sel_hi:[1,0,1]
    v_pk_fma_f32 v[84:85], v[84:85], v[6:7], v[6:7] op_sel:[0,0,1] op_sel_hi:[1,0,1]
    v_pk_fma_f32 v[86:87], v[86:87], v[6:7], v[6:7] op_sel:[0,0,1] op_sel_hi:[1,0,1]
    v_cvt_pk_bf16_f32 v16, v80, v81
    v_cvt_pk_bf16_f32 v17, v82, v83
    v_cvt_pk_bf16_f32 v18, v84, v85
    v_cvt_pk_bf16_f32 v19, v86, v87
    ds_write_b128 v12, v[16:19] offset:0
    v_lshlrev_b32 v80, 16, v20
    v_and_b32 v81, s69, v20
    v_lshlrev_b32 v82, 16, v21
    v_and_b32 v83, s69, v21
    v_lshlrev_b32 v84, 16, v22
    v_and_b32 v85, s69, v22
    v_lshlrev_b32 v86, 16, v23
    v_and_b32 v87, s69, v23
    v_pk_fma_f32 v[80:81], v[80:81], v[6:7], v[6:7] op_sel:[0,0,1] op_sel_hi:[1,0,1]
    v_pk_fma_f32 v[82:83], v[82:83], v[6:7], v[6:7] op_sel:[0,0,1] op_sel_hi:[1,0,1]
    v_pk_fma_f32 v[84:85], v[84:85], v[6:7], v[6:7] op_sel:[0,0,1] op_sel_hi:[1,0,1]
    v_pk_fma_f32 v[86:87], v[86:87], v[6:7], v[6:7] op_sel:[0,0,1] op_sel_hi:[1,0,1]
    v_cvt_pk_bf16_f32 v20, v80, v81
    v_cvt_pk_bf16_f32 v21, v82, v83
    v_cvt_pk_bf16_f32 v22, v84, v85
    v_cvt_pk_bf16_f32 v23, v86, v87
    ds_write_b128 v12, v[20:23] offset:128
    v_lshlrev_b32 v80, 16, v24
    v_and_b32 v81, s69, v24
    v_lshlrev_b32 v82, 16, v25
    v_and_b32 v83, s69, v25
    v_lshlrev_b32 v84, 16, v26
    v_and_b32 v85, s69, v26
    v_lshlrev_b32 v86, 16, v27
    v_and_b32 v87, s69, v27
    v_pk_fma_f32 v[80:81], v[80:81], v[6:7], v[6:7] op_sel:[0,0,1] op_sel_hi:[1,0,1]
    v_pk_fma_f32 v[82:83], v[82:83], v[6:7], v[6:7] op_sel:[0,0,1] op_sel_hi:[1,0,1]
    v_pk_fma_f32 v[84:85], v[84:85], v[6:7], v[6:7] op_sel:[0,0,1] op_sel_hi:[1,0,1]
    v_pk_fma_f32 v[86:87], v[86:87], v[6:7], v[6:7] op_sel:[0,0,1] op_sel_hi:[1,0,1]
    v_cvt_pk_bf16_f32 v24, v80, v81
    v_cvt_pk_bf16_f32 v25, v82, v83
    v_cvt_pk_bf16_f32 v26, v84, v85
    v_cvt_pk_bf16_f32 v27, v86, v87
    ds_write_b128 v12, v[24:27] offset:256
    v_lshlrev_b32 v80, 16, v28
    v_and_b32 v81, s69, v28
    v_lshlrev_b32 v82, 16, v29
    v_and_b32 v83, s69, v29
    v_lshlrev_b32 v84, 16, v30
    v_and_b32 v85, s69, v30
    v_lshlrev_b32 v86, 16, v31
    v_and_b32 v87, s69, v31
    v_pk_fma_f32 v[80:81], v[80:81], v[6:7], v[6:7] op_sel:[0,0,1] op_sel_hi:[1,0,1]
    v_pk_fma_f32 v[82:83], v[82:83], v[6:7], v[6:7] op_sel:[0,0,1] op_sel_hi:[1,0,1]
    s_add_u32 m0, s57, 77824
    s_nop 0
    buffer_load_dwordx4 v77, s[12:15], s61 offen  lds
    v_pk_fma_f32 v[84:85], v[84:85], v[6:7], v[6:7] op_sel:[0,0,1] op_sel_hi:[1,0,1]
    v_pk_fma_f32 v[86:87], v[86:87], v[6:7], v[6:7] op_sel:[0,0,1] op_sel_hi:[1,0,1]
    v_cvt_pk_bf16_f32 v28, v80, v81
    v_cvt_pk_bf16_f32 v29, v82, v83
    v_cvt_pk_bf16_f32 v30, v84, v85
    v_cvt_pk_bf16_f32 v31, v86, v87
    ds_write_b128 v12, v[28:31] offset:384
    v_lshlrev_b32 v80, 16, v32
    v_and_b32 v81, s69, v32
    v_lshlrev_b32 v82, 16, v33
    v_and_b32 v83, s69, v33
    v_lshlrev_b32 v84, 16, v34
    v_and_b32 v85, s69, v34
    v_lshlrev_b32 v86, 16, v35
    v_and_b32 v87, s69, v35
    v_pk_fma_f32 v[80:81], v[80:81], v[6:7], v[6:7] op_sel:[0,0,1] op_sel_hi:[1,0,1]
    v_pk_fma_f32 v[82:83], v[82:83], v[6:7], v[6:7] op_sel:[0,0,1] op_sel_hi:[1,0,1]
    v_pk_fma_f32 v[84:85], v[84:85], v[6:7], v[6:7] op_sel:[0,0,1] op_sel_hi:[1,0,1]
    v_pk_fma_f32 v[86:87], v[86:87], v[6:7], v[6:7] op_sel:[0,0,1] op_sel_hi:[1,0,1]
    v_cvt_pk_bf16_f32 v32, v80, v81
    v_cvt_pk_bf16_f32 v33, v82, v83
    v_cvt_pk_bf16_f32 v34, v84, v85
    v_cvt_pk_bf16_f32 v35, v86, v87
    ds_write_b128 v12, v[32:35] offset:512
    v_lshlrev_b32 v80, 16, v36
    v_and_b32 v81, s69, v36
    v_lshlrev_b32 v82, 16, v37
    v_and_b32 v83, s69, v37
    v_lshlrev_b32 v84, 16, v38
    v_and_b32 v85, s69, v38
    v_lshlrev_b32 v86, 16, v39
    v_and_b32 v87, s69, v39
    v_pk_fma_f32 v[80:81], v[80:81], v[6:7], v[6:7] op_sel:[0,0,1] op_sel_hi:[1,0,1]
    v_pk_fma_f32 v[82:83], v[82:83], v[6:7], v[6:7] op_sel:[0,0,1] op_sel_hi:[1,0,1]
    v_pk_fma_f32 v[84:85], v[84:85], v[6:7], v[6:7] op_sel:[0,0,1] op_sel_hi:[1,0,1]
    v_pk_fma_f32 v[86:87], v[86:87], v[6:7], v[6:7] op_sel:[0,0,1] op_sel_hi:[1,0,1]
    v_cvt_pk_bf16_f32 v36, v80, v81
    v_cvt_pk_bf16_f32 v37, v82, v83
    v_cvt_pk_bf16_f32 v38, v84, v85
    v_cvt_pk_bf16_f32 v39, v86, v87
    ds_write_b128 v12, v[36:39] offset:640
    v_lshlrev_b32 v80, 16, v40
    v_and_b32 v81, s69, v40
    v_lshlrev_b32 v82, 16, v41
    v_and_b32 v83, s69, v41
    v_lshlrev_b32 v84, 16, v42
    v_and_b32 v85, s69, v42
    v_lshlrev_b32 v86, 16, v43
    v_and_b32 v87, s69, v43
    v_pk_fma_f32 v[80:81], v[80:81], v[6:7], v[6:7] op_sel:[0,0,1] op_sel_hi:[1,0,1]
    v_pk_fma_f32 v[82:83], v[82:83], v[6:7], v[6:7] op_sel:[0,0,1] op_sel_hi:[1,0,1]
    v_pk_fma_f32 v[84:85], v[84:85], v[6:7], v[6:7] op_sel:[0,0,1] op_sel_hi:[1,0,1]
    v_pk_fma_f32 v[86:87], v[86:87], v[6:7], v[6:7] op_sel:[0,0,1] op_sel_hi:[1,0,1]
    v_cvt_pk_bf16_f32 v40, v80, v81
    v_cvt_pk_bf16_f32 v41, v82, v83
    v_cvt_pk_bf16_f32 v42, v84, v85
    v_cvt_pk_bf16_f32 v43, v86, v87
    ds_write_b128 v12, v[40:43] offset:768
    s_add_u32 m0, s57, 81920
    s_nop 0
    buffer_load_dwordx4 v78, s[12:15], s61 offen  lds
    buffer_store_dwordx4 v[216:219], v79, s[36:39], s96 offen sc1
    s_mov_b64 exec, 0xffffff
    buffer_store_dwordx4 v[220:223], v191, s[36:39], 0 offen sc1
    s_mov_b64 exec, -1
    s_cmp_lt_u32 s79, 28
    s_cbranch_scc1 Lcp1
    s_lshr_b32 s88, s46, 1
    s_lshl2_add_u32 s88, s88, s79
    s_sub_u32 s88, s88, 28
    s_and_b32 s77, s46, 1
    s_mul_i32 s77, s77, 14
    s_add_u32 s77, s77, s88
    s_cmp_ge_u32 s88, 14
    s_cselect_b32 s77, 28, s77
    s_lshl_b32 s3, s77, 11
    s_add_u32 s3, s3, 8781824
    s_lshl_b32 s47, s42, 9
    s_add_u32 s47, s47, s3
    s_lshr_b32 s87, s42, 1
    s_lshl_b32 s87, s87, 10
    s_lshl_b32 s88, s76, 3
    s_add_u32 s87, s87, s88
    s_add_u32 s3, s3, s87
    s_mov_b32 exec_hi, 0
    buffer_store_dwordx4 v[216:219], v2, s[36:39], s47 offen sc1
    s_mov_b64 exec, -1
Lcp1:
    v_mov_b32 v4, 0
    v_mov_b32 v5, 0
    v_mov_b32 v6, 0
    v_mov_b32 v7, 0
    s_waitcnt vmcnt(15)
    v_dot2c_f32_bf16 v4, s68, v44
    v_dot2c_f32_bf16 v5, v44, v44
    v_dot2c_f32_bf16 v6, s68, v45
    v_dot2c_f32_bf16 v7, v45, v45
    v_dot2c_f32_bf16 v4, s68, v46
    v_dot2c_f32_bf16 v5, v46, v46
    v_dot2c_f32_bf16 v6, s68, v47
    v_dot2c_f32_bf16 v7, v47, v47
    s_waitcnt vmcnt(14)
    v_dot2c_f32_bf16 v4, s68, v48
    v_dot2c_f32_bf16 v5, v48, v48
    v_dot2c_f32_bf16 v6, s68, v49
    v_dot2c_f32_bf16 v7, v49, v49
    v_dot2c_f32_bf16 v4, s68, v50
    v_dot2c_f32_bf16 v5, v50, v50
    v_dot2c_f32_bf16 v6, s68, v51
    v_dot2c_f32_bf16 v7, v51, v51
    s_waitcnt vmcnt(13)
    v_dot2c_f32_bf16 v4, s68, v52
    v_dot2c_f32_bf16 v5, v52, v52
    v_dot2c_f32_bf16 v6, s68, v53
    v_dot2c_f32_bf16 v7, v53, v53
    v_dot2c_f32_bf16 v4, s68, v54
    v_dot2c_f32_bf16 v5, v54, v54
    v_dot2c_f32_bf16 v6, s68, v55
    v_dot2c_f32_bf16 v7, v55, v55
    s_waitcnt vmcnt(12)
    v_dot2c_f32_bf16 v4, s68, v56
    v_dot2c_f32_bf16 v5, v56, v56
    v_dot2c_f32_bf16 v6, s68, v57
    v_dot2c_f32_bf16 v7, v57, v57
    v_dot2c_f32_bf16 v4, s68, v58
    v_dot2c_f32_bf16 v5, v58, v58
    v_dot2c_f32_bf16 v6, s68, v59
    v_dot2c_f32_bf16 v7, v59, v59
    s_waitcnt vmcnt(11)
    v_dot2c_f32_bf16 v4, s68, v60
    s_add_u32 m0, s57, 86016
    s_nop 0
    buffer_load_dwordx4 v72, s[12:15], s62 offen  lds
    v_dot2c_f32_bf16 v5, v60, v60
    v_dot2c_f32_bf16 v6, s68, v61
    v_dot2c_f32_bf16 v7, v61, v61
    v_dot2c_f32_bf16 v4, s68, v62
    v_dot2c_f32_bf16 v5, v62, v62
    v_dot2c_f32_bf16 v6, s68, v63
    v_dot2c_f32_bf16 v7, v63, v63
    s_waitcnt vmcnt(11)
    v_dot2c_f32_bf16 v4, s68, v64
    v_dot2c_f32_bf16 v5, v64, v64
    v_dot2c_f32_bf16 v6, s68, v65
    v_dot2c_f32_bf16 v7, v65, v65
    v_dot2c_f32_bf16 v4, s68, v66
    v_dot2c_f32_bf16 v5, v66, v66
    v_dot2c_f32_bf16 v6, s68, v67
    v_dot2c_f32_bf16 v7, v67, v67
    s_waitcnt vmcnt(10)
    v_dot2c_f32_bf16 v4, s68, v68
    v_dot2c_f32_bf16 v5, v68, v68
    v_dot2c_f32_bf16 v6, s68, v69
    v_dot2c_f32_bf16 v7, v69, v69
    v_dot2c_f32_bf16 v4, s68, v70
    v_dot2c_f32_bf16 v5, v70, v70
    v_dot2c_f32_bf16 v6, s68, v71
    v_dot2c_f32_bf16 v7, v71, v71
    s_nop 1
    v_add_f32 v4, v4, v6
    v_add_f32 v5, v5, v7
    s_nop 0
    v_add_f32_dpp v4, v4, v4 quad_perm:[1,0,3,2] row_mask:0xf bank_mask:0xf
    v_add_f32_dpp v5, v5, v5 quad_perm:[1,0,3,2] row_mask:0xf bank_mask:0xf
    s_nop 0
    v_add_f32_dpp v4, v4, v4 quad_perm:[2,3,0,1] row_mask:0xf bank_mask:0xf
    v_add_f32_dpp v5, v5, v5 quad_perm:[2,3,0,1] row_mask:0xf bank_mask:0xf
    s_nop 0
    v_add_f32_dpp v4, v4, v4 row_half_mirror row_mask:0xf bank_mask:0xf
    v_add_f32_dpp v5, v5, v5 row_half_mirror row_mask:0xf bank_mask:0xf
    v_mul_f32 v4, 0xbb124925, v4
    v_mul_f32 v6, v4, v4
    v_fma_f32 v5, v5, s70, -v6
    v_add_f32 v5, 0x3727c5ac, v5
    v_rsq_f32 v6, v5
    s_nop 0
    v_mul_f32 v7, v4, v6
    s_add_u32 m0, s57, 90112
    s_nop 0
    buffer_load_dwordx4 v73, s[12:15], s62 offen  lds
    v_lshlrev_b32 v80, 16, v44
    v_and_b32 v81, s69, v44
    v_lshlrev_b32 v82, 16, v45
    v_and_b32 v83, s69, v45
    v_lshlrev_b32 v84, 16, v46
    v_and_b32 v85, s69, v46
    v_lshlrev_b32 v86, 16, v47
    v_and_b32 v87, s69, v47
    v_pk_fma_f32 v[80:81], v[80:81], v[6:7], v[6:7] op_sel:[0,0,1] op_sel_hi:[1,0,1]
    v_pk_fma_f32 v[82:83], v[82:83], v[6:7], v[6:7] op_sel:[0,0,1] op_sel_hi:[1,0,1]
    v_pk_fma_f32 v[84:85], v[84:85], v[6:7], v[6:7] op_sel:[0,0,1] op_sel_hi:[1,0,1]
    v_pk_fma_f32 v[86:87], v[86:87], v[6:7], v[6:7] op_sel:[0,0,1] op_sel_hi:[1,0,1]
    v_cvt_pk_bf16_f32 v44, v80, v81
    v_cvt_pk_bf16_f32 v45, v82, v83
    v_cvt_pk_bf16_f32 v46, v84, v85
    v_cvt_pk_bf16_f32 v47, v86, v87
    ds_write_b128 v13, v[44:47] offset:0
    v_lshlrev_b32 v80, 16, v48
    v_and_b32 v81, s69, v48
    v_lshlrev_b32 v82, 16, v49
    v_and_b32 v83, s69, v49
    v_lshlrev_b32 v84, 16, v50
    v_and_b32 v85, s69, v50
    v_lshlrev_b32 v86, 16, v51
    v_and_b32 v87, s69, v51
    v_pk_fma_f32 v[80:81], v[80:81], v[6:7], v[6:7] op_sel:[0,0,1] op_sel_hi:[1,0,1]
    v_pk_fma_f32 v[82:83], v[82:83], v[6:7], v[6:7] op_sel:[0,0,1] op_sel_hi:[1,0,1]
    v_pk_fma_f32 v[84:85], v[84:85], v[6:7], v[6:7] op_sel:[0,0,1] op_sel_hi:[1,0,1]
    v_pk_fma_f32 v[86:87], v[86:87], v[6:7], v[6:7] op_sel:[0,0,1] op_sel_hi:[1,0,1]
    v_cvt_pk_bf16_f32 v48, v80, v81
    v_cvt_pk_bf16_f32 v49, v82, v83
    v_cvt_pk_bf16_f32 v50, v84, v85
    v_cvt_pk_bf16_f32 v51, v86, v87
    ds_write_b128 v13, v[48:51] offset:128
    v_lshlrev_b32 v80, 16, v52
    v_and_b32 v81, s69, v52
    s_add_u32 m0, s57, 94208
    s_nop 0
    buffer_load_dwordx4 v74, s[12:15], s62 offen  lds
    v_lshlrev_b32 v82, 16, v53
    v_and_b32 v83, s69, v53
    v_lshlrev_b32 v84, 16, v54
    v_and_b32 v85, s69, v54
    v_lshlrev_b32 v86, 16, v55
    v_and_b32 v87, s69, v55
    v_pk_fma_f32 v[80:81], v[80:81], v[6:7], v[6:7] op_sel:[0,0,1] op_sel_hi:[1,0,1]
    v_pk_fma_f32 v[82:83], v[82:83], v[6:7], v[6:7] op_sel:[0,0,1] op_sel_hi:[1,0,1]
    v_pk_fma_f32 v[84:85], v[84:85], v[6:7], v[6:7] op_sel:[0,0,1] op_sel_hi:[1,0,1]
    v_pk_fma_f32 v[86:87], v[86:87], v[6:7], v[6:7] op_sel:[0,0,1] op_sel_hi:[1,0,1]
    v_cvt_pk_bf16_f32 v52, v80, v81
    v_cvt_pk_bf16_f32 v53, v82, v83
    v_cvt_pk_bf16_f32 v54, v84, v85
    v_cvt_pk_bf16_f32 v55, v86, v87
    ds_write_b128 v13, v[52:55] offset:256
    v_lshlrev_b32 v80, 16, v56
    v_and_b32 v81, s69, v56
    v_lshlrev_b32 v82, 16, v57
    v_and_b32 v83, s69, v57
    v_lshlrev_b32 v84, 16, v58
    v_and_b32 v85, s69, v58
    v_lshlrev_b32 v86, 16, v59
    v_and_b32 v87, s69, v59
    v_pk_fma_f32 v[80:81], v[80:81], v[6:7], v[6:7] op_sel:[0,0,1] op_sel_hi:[1,0,1]
    v_pk_fma_f32 v[82:83], v[82:83], v[6:7], v[6:7] op_sel:[0,0,1] op_sel_hi:[1,0,1]
    v_pk_fma_f32 v[84:85], v[84:85], v[6:7], v[6:7] op_sel:[0,0,1] op_sel_hi:[1,0,1]
    v_pk_fma_f32 v[86:87], v[86:87], v[6:7], v[6:7] op_sel:[0,0,1] op_sel_hi:[1,0,1]
    v_cvt_pk_bf16_f32 v56, v80, v81
    v_cvt_pk_bf16_f32 v57, v82, v83
    v_cvt_pk_bf16_f32 v58, v84, v85
    v_cvt_pk_bf16_f32 v59, v86, v87
    ds_write_b128 v13, v[56:59] offset:384
    v_lshlrev_b32 v80, 16, v60
    v_and_b32 v81, s69, v60
    v_lshlrev_b32 v82, 16, v61
    v_and_b32 v83, s69, v61
    v_lshlrev_b32 v84, 16, v62
    s_cmp_ge_u32 s42, 2
    s_cselect_b32 s47, s63, s62
    s_add_u32 m0, s57, 98304
    s_nop 0
    buffer_load_dwordx4 v75, s[12:15], s47 offen  lds
    v_and_b32 v85, s69, v62
    v_lshlrev_b32 v86, 16, v63
    v_and_b32 v87, s69, v63
    v_pk_fma_f32 v[80:81], v[80:81], v[6:7], v[6:7] op_sel:[0,0,1] op_sel_hi:[1,0,1]
    v_pk_fma_f32 v[82:83], v[82:83], v[6:7], v[6:7] op_sel:[0,0,1] op_sel_hi:[1,0,1]
    v_pk_fma_f32 v[84:85], v[84:85], v[6:7], v[6:7] op_sel:[0,0,1] op_sel_hi:[1,0,1]
    v_pk_fma_f32 v[86:87], v[86:87], v[6:7], v[6:7] op_sel:[0,0,1] op_sel_hi:[1,0,1]
    v_cvt_pk_bf16_f32 v60, v80, v81
    v_cvt_pk_bf16_f32 v61, v82, v83
    v_cvt_pk_bf16_f32 v62, v84, v85
    v_cvt_pk_bf16_f32 v63, v86, v87
    ds_write_b128 v13, v[60:63] offset:512
    v_lshlrev_b32 v80, 16, v64
    v_and_b32 v81, s69, v64
    v_lshlrev_b32 v82, 16, v65
    v_and_b32 v83, s69, v65
    v_lshlrev_b32 v84, 16, v66
    v_and_b32 v85, s69, v66
    v_lshlrev_b32 v86, 16, v67
    v_and_b32 v87, s69, v67
    v_pk_fma_f32 v[80:81], v[80:81], v[6:7], v[6:7] op_sel:[0,0,1] op_sel_hi:[1,0,1]
    v_pk_fma_f32 v[82:83], v[82:83], v[6:7], v[6:7] op_sel:[0,0,1] op_sel_hi:[1,0,1]
    v_pk_fma_f32 v[84:85], v[84:85], v[6:7], v[6:7] op_sel:[0,0,1] op_sel_hi:[1,0,1]
    v_pk_fma_f32 v[86:87], v[86:87], v[6:7], v[6:7] op_sel:[0,0,1] op_sel_hi:[1,0,1]
    v_cvt_pk_bf16_f32 v64, v80, v81
    v_cvt_pk_bf16_f32 v65, v82, v83
    v_cvt_pk_bf16_f32 v66, v84, v85
    v_cvt_pk_bf16_f32 v67, v86, v87
    ds_write_b128 v13, v[64:67] offset:640
    v_lshlrev_b32 v80, 16, v68
    v_and_b32 v81, s69, v68
    v_lshlrev_b32 v82, 16, v69
    v_and_b32 v83, s69, v69
    v_lshlrev_b32 v84, 16, v70
    v_and_b32 v85, s69, v70
    v_lshlrev_b32 v86, 16, v71
    s_add_u32 m0, s57, 102400
    s_nop 0
    buffer_load_dwordx4 v76, s[12:15], s63 offen  lds
    v_and_b32 v87, s69, v71
    v_pk_fma_f32 v[80:81], v[80:81], v[6:7], v[6:7] op_sel:[0,0,1] op_sel_hi:[1,0,1]
    v_pk_fma_f32 v[82:83], v[82:83], v[6:7], v[6:7] op_sel:[0,0,1] op_sel_hi:[1,0,1]
    v_pk_fma_f32 v[84:85], v[84:85], v[6:7], v[6:7] op_sel:[0,0,1] op_sel_hi:[1,0,1]
    v_pk_fma_f32 v[86:87], v[86:87], v[6:7], v[6:7] op_sel:[0,0,1] op_sel_hi:[1,0,1]
    v_cvt_pk_bf16_f32 v68, v80, v81
    v_cvt_pk_bf16_f32 v69, v82, v83
    v_cvt_pk_bf16_f32 v70, v84, v85
    v_cvt_pk_bf16_f32 v71, v86, v87
    ds_write_b128 v13, v[68:71] offset:768
    s_waitcnt vmcnt(5) lgkmcnt(0)
    s_barrier
    s_cmp_lg_u32 s42, 0
    s_cbranch_scc1 Lsig2
    s_and_b32 s87, s2, 1
    s_lshl_b32 s87, s87, 7
    s_mov_b32 s45, 1
    s_atomic_add s45, s[40:41], s87
Lsig2:
    ds_read_b128 a[0:3], v88 offset:0
    ds_read_b64_tr_b16 v[152:153], v92 offset:0
    ds_read_b64_tr_b16 v[154:155], v92 offset:224
    ds_read_b64_tr_b16 v[156:157], v92 offset:112
    ds_read_b64_tr_b16 v[158:159], v92 offset:336
    ds_read_b128 a[4:7], v89 offset:0
    ds_read_b64_tr_b16 v[160:161], v92 offset:3584
    ds_read_b128 a[12:15], v91 offset:0
    ds_read_b64_tr_b16 v[162:163], v92 offset:3808
    ds_read_b128 a[16:19], v88 offset:128
    ds_read_b64_tr_b16 v[164:165], v92 offset:3696
    s_add_u32 m0, s57, 106496
    s_nop 0
    buffer_load_dwordx4 v77, s[12:15], s63 offen  lds
    ds_read_b128 a[20:23], v89 offset:128
    ds_read_b64_tr_b16 v[166:167], v92 offset:3920
    ds_read_b128 a[24:27], v90 offset:128
    ds_read_b128 a[8:11], v90 offset:0
    ds_read_b128 a[28:31], v91 offset:128
    ds_read_b64_tr_b16 v[168:169], v92 offset:7168
    ds_read_b64_tr_b16 v[170:171], v92 offset:7392
    ds_read_b128 a[32:35], v88 offset:256
    s_waitcnt lgkmcnt(15)
    v_mfma_f32_32x32x16_bf16 v[96:111], a[0:3], v[152:155], 0
    ds_read_b128 a[36:39], v89 offset:256
    ds_read_b64_tr_b16 v[172:173], v92 offset:7280
    s_add_u32 m0, s57, 110592
    s_nop 0
    buffer_load_dwordx4 v78, s[12:15], s63 offen  lds
    ds_read_b128 a[40:43], v90 offset:256
    ds_read_b64_tr_b16 v[174:175], v92 offset:7504
    ds_read_b128 a[44:47], v91 offset:256
    s_waitcnt lgkmcnt(15)
    v_mfma_f32_32x32x16_bf16 v[112:127], a[0:3], v[156:159], 0
    ds_read_b128 a[48:51], v88 offset:384
    ds_read_b64_tr_b16 v[176:177], v92 offset:10752
    ds_read_b64_tr_b16 v[178:179], v92 offset:10976
    ds_read_b128 a[52:55], v89 offset:384
    v_mfma_f32_32x32x16_bf16 v[96:111], a[4:7], v[160:163], v[96:111]
    ds_read_b128 a[56:59], v90 offset:384
    s_add_u32 m0, s57, 114688
    s_nop 0
    buffer_load_dwordx4 v72, s[12:15], s64 offen  lds
    ds_read_b64_tr_b16 v[180:181], v92 offset:10864
    ds_read_b128 a[60:63], v91 offset:384
    ds_read_b64_tr_b16 v[182:183], v92 offset:11088
    ds_read_b128 a[64:67], v88 offset:512
    s_waitcnt lgkmcnt(15)
    v_mfma_f32_32x32x16_bf16 v[112:127], a[4:7], v[164:167], v[112:127]
    ds_read_b128 a[68:71], v89 offset:512
    ds_read_b64_tr_b16 v[152:153], v92 offset:14336
    ds_read_b64_tr_b16 v[154:155], v92 offset:14560
    ds_read_b128 a[72:75], v90 offset:512
    v_mfma_f32_32x32x16_bf16 v[96:111], a[8:11], v[168:171], v[96:111]
    ds_read_b128 a[76:79], v91 offset:512
    s_add_u32 m0, s57, 118784
    s_nop 0
    buffer_load_dwordx4 v73, s[12:15], s64 offen  lds
    ds_read_b64_tr_b16 v[156:157], v92 offset:14448
    ds_read_b128 a[80:83], v88 offset:640
    ds_read_b64_tr_b16 v[158:159], v92 offset:14672
    ds_read_b128 a[84:87], v89 offset:640
    s_waitcnt lgkmcnt(15)
    v_mfma_f32_32x32x16_bf16 v[112:127], a[8:11], v[172:175], v[112:127]
    ds_read_b128 a[88:91], v90 offset:640
    ds_read_b64_tr_b16 v[160:161], v92 offset:17920
    ds_read_b64_tr_b16 v[162:163], v92 offset:18144
    ds_read_b128 a[92:95], v91 offset:640
    v_mfma_f32_32x32x16_bf16 v[96:111], a[12:15], v[176:179], v[96:111]
    ds_read_b128 a[96:99], v88 offset:768
    s_add_u32 m0, s57, 122880
    s_nop 0
    buffer_load_dwordx4 v74, s[12:15], s64 offen  lds
    ds_read_b64_tr_b16 v[164:165], v92 offset:18032
    ds_read_b128 a[100:103], v89 offset:768
    ds_read_b64_tr_b16 v[166:167], v92 offset:18256
    ds_read_b128 a[104:107], v90 offset:768
    s_waitcnt lgkmcnt(15)
    v_mfma_f32_32x32x16_bf16 v[112:127], a[12:15], v[180:183], v[112:127]
    ds_read_b128 a[108:111], v91 offset:768
    ds_read_b64_tr_b16 v[168:169], v92 offset:21504
    ds_read_b64_tr_b16 v[170:171], v92 offset:21728
    v_mfma_f32_32x32x16_bf16 v[96:111], a[16:19], v[152:155], v[96:111]
    ds_read_b64_tr_b16 v[172:173], v92 offset:21616
    s_cmp_ge_u32 s42, 2
    s_cselect_b32 s47, s65, s64
    s_add_u32 m0, s57, 126976
    s_nop 0
    buffer_load_dwordx4 v75, s[12:15], s47 offen  lds
    ds_read_b64_tr_b16 v[174:175], v92 offset:21840
    s_waitcnt lgkmcnt(15)
    v_mfma_f32_32x32x16_bf16 v[112:127], a[16:19], v[156:159], v[112:127]
    ds_read_b64_tr_b16 v[176:177], v92 offset:25088
    ds_read_b64_tr_b16 v[178:179], v92 offset:25312
    s_waitcnt lgkmcnt(13)
    v_mfma_f32_32x32x16_bf16 v[96:111], a[20:23], v[160:163], v[96:111]
    ds_read_b64_tr_b16 v[180:181], v92 offset:25200
    ds_read_b64_tr_b16 v[182:183], v92 offset:25424
    s_waitcnt lgkmcnt(10)
    v_mfma_f32_32x32x16_bf16 v[112:127], a[20:23], v[164:167], v[112:127]
    s_waitcnt lgkmcnt(8)
    s_waitcnt vmcnt(7)
    s_barrier
    ds_read_b64_tr_b16 v[152:153], v92 offset:28672
    ds_read_b64_tr_b16 v[154:155], v92 offset:28896
    s_waitcnt lgkmcnt(8)
    v_mfma_f32_32x32x16_bf16 v[96:111], a[24:27], v[168:171], v[96:111]
    ds_read_b64_tr_b16 v[156:157], v92 offset:28784
    ds_read_b64_tr_b16 v[158:159], v92 offset:29008
    s_waitcnt lgkmcnt(8)
    v_mfma_f32_32x32x16_bf16 v[112:127], a[24:27], v[172:175], v[112:127]
    s_add_u32 m0, s57, 131072
    s_nop 0
    buffer_load_dwordx4 v76, s[12:15], s65 offen  lds
    ds_read_b64_tr_b16 v[160:161], v92 offset:32256
    ds_read_b64_tr_b16 v[162:163], v92 offset:32480
    s_waitcnt lgkmcnt(8)
    v_mfma_f32_32x32x16_bf16 v[96:111], a[28:31], v[176:179], v[96:111]
    ds_read_b64_tr_b16 v[164:165], v92 offset:32368
    ds_read_b64_tr_b16 v[166:167], v92 offset:32592
    s_add_u32 m0, s57, 135168
    s_nop 0
    buffer_load_dwordx4 v77, s[12:15], s65 offen  lds
    s_waitcnt lgkmcnt(8)
    v_mfma_f32_32x32x16_bf16 v[112:127], a[28:31], v[180:183], v[112:127]
    ds_read_b64_tr_b16 v[168:169], v92 offset:35840
    ds_read_b64_tr_b16 v[170:171], v92 offset:36064
    s_waitcnt lgkmcnt(8)
    v_mfma_f32_32x32x16_bf16 v[96:111], a[32:35], v[152:155], v[96:111]
    ds_read_b64_tr_b16 v[172:173], v92 offset:35952
    s_add_u32 m0, s57, 139264
    s_nop 0
    buffer_load_dwordx4 v78, s[12:15], s65 offen  lds
    ds_read_b64_tr_b16 v[174:175], v92 offset:36176
    s_waitcnt lgkmcnt(8)
    v_mfma_f32_32x32x16_bf16 v[112:127], a[32:35], v[156:159], v[112:127]
    ds_read_b64_tr_b16 v[176:177], v92 offset:39424
    ds_read_b64_tr_b16 v[178:179], v92 offset:39648
    s_waitcnt lgkmcnt(8)
    v_mfma_f32_32x32x16_bf16 v[96:111], a[36:39], v[160:163], v[96:111]
    s_add_u32 m0, s57, 143360
    s_nop 0
    buffer_load_dwordx4 v72, s[12:15], s66 offen  lds
    ds_read_b64_tr_b16 v[180:181], v92 offset:39536
    ds_read_b64_tr_b16 v[182:183], v92 offset:39760
    s_waitcnt lgkmcnt(8)
    v_mfma_f32_32x32x16_bf16 v[112:127], a[36:39], v[164:167], v[112:127]
    s_waitcnt vmcnt(8)
    s_barrier
    ds_read_b64_tr_b16 v[152:153], v92 offset:43008
    ds_read_b64_tr_b16 v[154:155], v92 offset:43232
    s_waitcnt lgkmcnt(8)
    v_mfma_f32_32x32x16_bf16 v[96:111], a[40:43], v[168:171], v[96:111]
    ds_read_b64_tr_b16 v[156:157], v92 offset:43120
    ds_read_b64_tr_b16 v[158:159], v92 offset:43344
    s_waitcnt lgkmcnt(8)
    v_mfma_f32_32x32x16_bf16 v[112:127], a[40:43], v[172:175], v[112:127]
    ds_read_b64_tr_b16 v[160:161], v92 offset:46592
    s_add_u32 m0, s57, 147456
    s_nop 0
    buffer_load_dwordx4 v73, s[12:15], s66 offen  lds
    ds_read_b64_tr_b16 v[162:163], v92 offset:46816
    s_waitcnt lgkmcnt(8)
    v_mfma_f32_32x32x16_bf16 v[96:111], a[44:47], v[176:179], v[96:111]
    ds_read_b64_tr_b16 v[164:165], v92 offset:46704
    ds_read_b64_tr_b16 v[166:167], v92 offset:46928
    s_waitcnt lgkmcnt(8)
    v_mfma_f32_32x32x16_bf16 v[112:127], a[44:47], v[180:183], v[112:127]
    ds_read_b64_tr_b16 v[168:169], v92 offset:50176
    ds_read_b64_tr_b16 v[170:171], v92 offset:50400
    s_add_u32 m0, s57, 151552
    s_nop 0
    buffer_load_dwordx4 v74, s[12:15], s66 offen  lds
    s_waitcnt lgkmcnt(8)
    v_mfma_f32_32x32x16_bf16 v[96:111], a[48:51], v[152:155], v[96:111]
    ds_read_b64_tr_b16 v[172:173], v92 offset:50288
    ds_read_b64_tr_b16 v[174:175], v92 offset:50512
    s_waitcnt lgkmcnt(8)
    v_mfma_f32_32x32x16_bf16 v[112:127], a[48:51], v[156:159], v[112:127]
    ds_read_b64_tr_b16 v[176:177], v92 offset:53760
    ds_read_b64_tr_b16 v[178:179], v92 offset:53984
    s_waitcnt lgkmcnt(8)
    v_mfma_f32_32x32x16_bf16 v[96:111], a[52:55], v[160:163], v[96:111]
    s_cmp_ge_u32 s42, 2
    s_cselect_b32 s47, s67, s66
    s_add_u32 m0, s57, 155648
    s_nop 0
    buffer_load_dwordx4 v75, s[12:15], s47 offen  lds
    ds_read_b64_tr_b16 v[180:181], v92 offset:53872
    ds_read_b64_tr_b16 v[182:183], v92 offset:54096
    s_waitcnt lgkmcnt(8)
    v_mfma_f32_32x32x16_bf16 v[112:127], a[52:55], v[164:167], v[112:127]
    s_waitcnt vmcnt(7)
    s_barrier
    s_mov_b32 s30, 0x188000
    s_mov_b32 s31, 0x20000
    s_mov_b32 s50, 86016
    s_cmp_ge_u32 s79, 28
    s_cselect_b64 s[4:5], s[28:29], s[12:13]
    s_cselect_b32 s6, s30, s14
    s_cselect_b32 s50, 7168, s50
    s_mov_b32 s7, 0x20000
    s_mov_b32 s52, s57
    s_add_u32 s51, s57, 4096
    s_cmp_lt_u32 s79, 28
    s_cbranch_scc1 Lqs3
    s_lshl_b32 s87, s77, 2
    s_add_u32 s87, s87, s42
    s_mul_i32 s87, s87, 14336
    s_lshl_b32 s52, s42, 11
    s_add_u32 s51, s52, 1024
    v_mov_b32 v95, v14
    s_add_u32 s60, s87, 0
    s_add_u32 s61, s87, 128
    s_add_u32 s62, s87, 256
    s_add_u32 s63, s87, 384
    s_add_u32 s64, s87, 512
    s_add_u32 s65, s87, 640
    s_add_u32 s66, s87, 768
Lqs3:
    ds_read_b64_tr_b16 v[152:153], v93 offset:0
    ds_read_b64_tr_b16 v[154:155], v93 offset:224
    s_waitcnt lgkmcnt(8)
    v_mfma_f32_32x32x16_bf16 v[96:111], a[56:59], v[168:171], v[96:111]
    ds_read_b64_tr_b16 v[156:157], v93 offset:112
    ds_read_b64_tr_b16 v[158:159], v93 offset:336
    s_waitcnt lgkmcnt(8)
    v_mfma_f32_32x32x16_bf16 v[112:127], a[56:59], v[172:175], v[112:127]
    s_add_u32 m0, s52, 0
    s_nop 0
    buffer_load_dwordx4 v95, s[4:7], s60 offen  lds
    ds_read_b64_tr_b16 v[160:161], v93 offset:3584
    ds_read_b64_tr_b16 v[162:163], v93 offset:3808
    s_waitcnt lgkmcnt(8)
    v_mfma_f32_32x32x16_bf16 v[96:111], a[60:63], v[176:179], v[96:111]
    ds_read_b64_tr_b16 v[164:165], v93 offset:3696
    ds_read_b64_tr_b16 v[166:167], v93 offset:3920
    s_add_u32 s47, s60, s50
    s_add_u32 m0, s51, 0
    s_nop 0
    buffer_load_dwordx4 v95, s[4:7], s47 offen  lds
    s_waitcnt lgkmcnt(8)
    v_mfma_f32_32x32x16_bf16 v[112:127], a[60:63], v[180:183], v[112:127]
    ds_read_b64_tr_b16 v[168:169], v93 offset:7168
    ds_read_b64_tr_b16 v[170:171], v93 offset:7392
    s_waitcnt lgkmcnt(8)
    v_mfma_f32_32x32x16_bf16 v[96:111], a[64:67], v[152:155], v[96:111]
    ds_read_b64_tr_b16 v[172:173], v93 offset:7280
    s_add_u32 m0, s52, 8192
    s_nop 0
    buffer_load_dwordx4 v95, s[4:7], s61 offen  lds
    ds_read_b64_tr_b16 v[174:175], v93 offset:7504
    s_waitcnt lgkmcnt(8)
    v_mfma_f32_32x32x16_bf16 v[112:127], a[64:67], v[156:159], v[112:127]
    ds_read_b64_tr_b16 v[176:177], v93 offset:10752
    ds_read_b64_tr_b16 v[178:179], v93 offset:10976
    s_waitcnt lgkmcnt(8)
    v_mfma_f32_32x32x16_bf16 v[96:111], a[68:71], v[160:163], v[96:111]
    s_add_u32 s47, s61, s50
    s_add_u32 m0, s51, 8192
    s_nop 0
    buffer_load_dwordx4 v95, s[4:7], s47 offen  lds
    ds_read_b64_tr_b16 v[180:181], v93 offset:10864
    ds_read_b64_tr_b16 v[182:183], v93 offset:11088
    s_waitcnt lgkmcnt(8)
    v_mfma_f32_32x32x16_bf16 v[112:127], a[68:71], v[164:167], v[112:127]
    s_waitcnt vmcnt(8)
    s_barrier
    ds_read_b64_tr_b16 v[152:153], v93 offset:14336
    ds_read_b64_tr_b16 v[154:155], v93 offset:14560
    s_waitcnt lgkmcnt(8)
    v_mfma_f32_32x32x16_bf16 v[96:111], a[72:75], v[168:171], v[96:111]
    ds_read_b64_tr_b16 v[156:157], v93 offset:14448
    ds_read_b64_tr_b16 v[158:159], v93 offset:14672
    s_waitcnt lgkmcnt(8)
    v_mfma_f32_32x32x16_bf16 v[112:127], a[72:75], v[172:175], v[112:127]
    s_add_u32 m0, s52, 16384
    s_nop 0
    buffer_load_dwordx4 v95, s[4:7], s62 offen  lds
    ds_read_b64_tr_b16 v[160:161], v93 offset:17920
    ds_read_b64_tr_b16 v[162:163], v93 offset:18144
    s_waitcnt lgkmcnt(8)
    v_mfma_f32_32x32x16_bf16 v[96:111], a[76:79], v[176:179], v[96:111]
    ds_read_b64_tr_b16 v[164:165], v93 offset:18032
    ds_read_b64_tr_b16 v[166:167], v93 offset:18256
    s_add_u32 s47, s62, s50
    s_add_u32 m0, s51, 16384
    s_nop 0
    buffer_load_dwordx4 v95, s[4:7], s47 offen  lds
    s_waitcnt lgkmcnt(8)
    v_mfma_f32_32x32x16_bf16 v[112:127], a[76:79], v[180:183], v[112:127]
    ds_read_b64_tr_b16 v[168:169], v93 offset:21504
    ds_read_b64_tr_b16 v[170:171], v93 offset:21728
    s_waitcnt lgkmcnt(8)
    v_mfma_f32_32x32x16_bf16 v[96:111], a[80:83], v[152:155], v[96:111]
    ds_read_b64_tr_b16 v[172:173], v93 offset:21616
    s_add_u32 m0, s52, 24576
    s_nop 0
    buffer_load_dwordx4 v95, s[4:7], s63 offen  lds
    ds_read_b64_tr_b16 v[174:175], v93 offset:21840
    s_waitcnt lgkmcnt(8)
    v_mfma_f32_32x32x16_bf16 v[112:127], a[80:83], v[156:159], v[112:127]
    ds_read_b64_tr_b16 v[176:177], v93 offset:25088
    ds_read_b64_tr_b16 v[178:179], v93 offset:25312
    s_waitcnt lgkmcnt(8)
    v_mfma_f32_32x32x16_bf16 v[96:111], a[84:87], v[160:163], v[96:111]
    s_add_u32 s47, s63, s50
    s_add_u32 m0, s51, 24576
    s_nop 0
    buffer_load_dwordx4 v95, s[4:7], s47 offen  lds
    ds_read_b64_tr_b16 v[180:181], v93 offset:25200
    ds_read_b64_tr_b16 v[182:183], v93 offset:25424
    s_waitcnt lgkmcnt(8)
    v_mfma_f32_32x32x16_bf16 v[112:127], a[84:87], v[164:167], v[112:127]
    s_waitcnt vmcnt(8)
    s_barrier
    ds_read_b64_tr_b16 v[152:153], v93 offset:28672
    ds_read_b64_tr_b16 v[154:155], v93 offset:28896
    s_waitcnt lgkmcnt(8)
    v_mfma_f32_32x32x16_bf16 v[96:111], a[88:91], v[168:171], v[96:111]
    ds_read_b64_tr_b16 v[156:157], v93 offset:28784
    ds_read_b64_tr_b16 v[158:159], v93 offset:29008
    s_waitcnt lgkmcnt(8)
    v_mfma_f32_32x32x16_bf16 v[112:127], a[88:91], v[172:175], v[112:127]
    ds_read_b64_tr_b16 v[160:161], v93 offset:32256
    ds_read_b64_tr_b16 v[162:163], v93 offset:32480
    s_waitcnt lgkmcnt(8)
    v_mfma_f32_32x32x16_bf16 v[96:111], a[92:95], v[176:179], v[96:111]
    ds_read_b64_tr_b16 v[164:165], v93 offset:32368
    ds_read_b64_tr_b16 v[166:167], v93 offset:32592
    s_waitcnt lgkmcnt(8)
    v_mfma_f32_32x32x16_bf16 v[112:127], a[92:95], v[180:183], v[112:127]
    ds_read_b64_tr_b16 v[168:169], v93 offset:35840
    ds_read_b64_tr_b16 v[170:171], v93 offset:36064
    s_waitcnt lgkmcnt(8)
    v_mfma_f32_32x32x16_bf16 v[96:111], a[96:99], v[152:155], v[96:111]
    ds_read_b64_tr_b16 v[172:173], v93 offset:35952
    ds_read_b64_tr_b16 v[174:175], v93 offset:36176
    s_waitcnt lgkmcnt(8)
    v_mfma_f32_32x32x16_bf16 v[112:127], a[96:99], v[156:159], v[112:127]
    ds_read_b64_tr_b16 v[176:177], v93 offset:39424
    ds_read_b64_tr_b16 v[178:179], v93 offset:39648
    s_waitcnt lgkmcnt(8)
    v_mfma_f32_32x32x16_bf16 v[96:111], a[100:103], v[160:163], v[96:111]
    ds_read_b64_tr_b16 v[180:181], v93 offset:39536
    ds_read_b64_tr_b16 v[182:183], v93 offset:39760
    s_waitcnt lgkmcnt(8)
    v_mfma_f32_32x32x16_bf16 v[112:127], a[100:103], v[164:167], v[112:127]
    ds_read_b32 v3, v2
    s_waitcnt lgkmcnt(7)
    v_mfma_f32_32x32x16_bf16 v[96:111], a[104:107], v[168:171], v[96:111]
    s_lshl_b32 s88, s76, 2
    v_and_b32 v4, 31, v0
    v_subrev_u32 v5, s88, v4
    s_waitcnt lgkmcnt(3)
    v_mfma_f32_32x32x16_bf16 v[96:111], a[108:111], v[176:179], v[96:111]
    v_cmp_gt_u32 vcc, 28, v5
    v_mov_b32 v7, 1.0
    s_xor_b32 s87, s76, 1
    v_mfma_f32_32x32x16_bf16 v[112:127], a[104:107], v[172:175], v[112:127]
    s_mul_i32 s87, s87, 28
    v_cndmask_b32 v184, 0, v7, vcc
    v_cmp_eq_u32 vcc, s87, v4
    s_waitcnt lgkmcnt(1)
    v_mfma_f32_32x32x16_bf16 v[112:127], a[108:111], v[180:183], v[112:127]
    v_mul_f32 v185, 0x358637bd, v184
    v_mov_b32 v186, v184
    v_cndmask_b32 v187, 0, v7, vcc
    s_cmp_ge_u32 s79, 28
    s_cbranch_scc1 Lnq4
    s_add_u32 m0, s52, 32768
    s_nop 0
    buffer_load_dwordx4 v95, s[4:7], s64 offen  lds
    s_add_u32 s47, s64, s50
    s_add_u32 m0, s51, 32768
    s_nop 0
    buffer_load_dwordx4 v95, s[4:7], s47 offen  lds
    s_add_u32 m0, s52, 40960
    s_nop 0
    buffer_load_dwordx4 v95, s[4:7], s65 offen  lds
    s_add_u32 s47, s65, s50
    s_add_u32 m0, s51, 40960
    s_nop 0
    buffer_load_dwordx4 v95, s[4:7], s47 offen  lds
    s_add_u32 m0, s52, 49152
    s_nop 0
    buffer_load_dwordx4 v95, s[4:7], s66 offen  lds
    s_add_u32 s47, s66, s50
    s_add_u32 m0, s51, 49152
    s_nop 0
    buffer_load_dwordx4 v95, s[4:7], s47 offen  lds
Lnq4:
    v_pk_mul_f32 v[16:17], v[96:97], s[70:71] op_sel:[0,1]
    v_pk_mul_f32 v[18:19], v[98:99], s[70:71] op_sel:[0,1]
    v_pk_mul_f32 v[20:21], v[100:101], s[70:71] op_sel:[0,1]
    v_pk_mul_f32 v[22:23], v[102:103], s[70:71] op_sel:[0,1]
    v_pk_mul_f32 v[24:25], v[104:105], s[70:71] op_sel:[0,1]
    v_pk_mul_f32 v[26:27], v[106:107], s[70:71] op_sel:[0,1]
    v_pk_mul_f32 v[28:29], v[108:109], s[70:71] op_sel:[0,1]
    v_pk_mul_f32 v[30:31], v[110:111], s[70:71] op_sel:[0,1]
    v_exp_f32_e64 v16, v16 clamp
    v_max_f32 v96, 0, v96
    v_exp_f32_e64 v17, v17 clamp
    v_max_f32 v97, 0, v97
    v_exp_f32_e64 v18, v18 clamp
    v_max_f32 v98, 0, v98
    v_exp_f32_e64 v19, v19 clamp
    v_max_f32 v99, 0, v99
    v_exp_f32_e64 v20, v20 clamp
    v_max_f32 v100, 0, v100
    v_exp_f32_e64 v21, v21 clamp
    v_max_f32 v101, 0, v101
    v_exp_f32_e64 v22, v22 clamp
    v_max_f32 v102, 0, v102
    v_exp_f32_e64 v23, v23 clamp
    v_max_f32 v103, 0, v103
    v_exp_f32_e64 v24, v24 clamp
    v_max_f32 v104, 0, v104
    v_exp_f32_e64 v25, v25 clamp
    v_max_f32 v105, 0, v105
    v_exp_f32_e64 v26, v26 clamp
    v_max_f32 v106, 0, v106
    v_exp_f32_e64 v27, v27 clamp
    v_max_f32 v107, 0, v107
    v_exp_f32_e64 v28, v28 clamp
    v_max_f32 v108, 0, v108
    v_exp_f32_e64 v29, v29 clamp
    v_max_f32 v109, 0, v109
    v_exp_f32_e64 v30, v30 clamp
    v_max_f32 v110, 0, v110
    v_exp_f32_e64 v31, v31 clamp
    v_max_f32 v111, 0, v111
    v_pk_add_f32 v[16:17], v[16:17], v[96:97]
    v_pk_add_f32 v[18:19], v[18:19], v[98:99]
    v_pk_add_f32 v[20:21], v[20:21], v[100:101]
    v_pk_add_f32 v[22:23], v[22:23], v[102:103]
    v_pk_add_f32 v[24:25], v[24:25], v[104:105]
    v_pk_add_f32 v[26:27], v[26:27], v[106:107]
    v_pk_add_f32 v[28:29], v[28:29], v[108:109]
    v_pk_add_f32 v[30:31], v[30:31], v[110:111]
    v_pk_fma_f32 v[16:17], v[16:17], v[184:185], v[184:185] op_sel:[0,0,1] op_sel_hi:[1,0,1]
    v_pk_fma_f32 v[18:19], v[18:19], v[184:185], v[184:185] op_sel:[0,0,1] op_sel_hi:[1,0,1]
    v_pk_fma_f32 v[20:21], v[20:21], v[184:185], v[184:185] op_sel:[0,0,1] op_sel_hi:[1,0,1]
    v_pk_fma_f32 v[22:23], v[22:23], v[184:185], v[184:185] op_sel:[0,0,1] op_sel_hi:[1,0,1]
    v_pk_fma_f32 v[24:25], v[24:25], v[184:185], v[184:185] op_sel:[0,0,1] op_sel_hi:[1,0,1]
    v_pk_fma_f32 v[26:27], v[26:27], v[184:185], v[184:185] op_sel:[0,0,1] op_sel_hi:[1,0,1]
    v_pk_fma_f32 v[28:29], v[28:29], v[184:185], v[184:185] op_sel:[0,0,1] op_sel_hi:[1,0,1]
    v_pk_fma_f32 v[30:31], v[30:31], v[184:185], v[184:185] op_sel:[0,0,1] op_sel_hi:[1,0,1]
    v_pk_fma_f32 v[112:113], v[112:113], v[186:187], v[186:187] op_sel:[0,0,1] op_sel_hi:[1,0,1]
    v_pk_fma_f32 v[114:115], v[114:115], v[186:187], v[186:187] op_sel:[0,0,1] op_sel_hi:[1,0,1]
    v_pk_fma_f32 v[116:117], v[116:117], v[186:187], v[186:187] op_sel:[0,0,1] op_sel_hi:[1,0,1]
    v_pk_fma_f32 v[118:119], v[118:119], v[186:187], v[186:187] op_sel:[0,0,1] op_sel_hi:[1,0,1]
    v_pk_fma_f32 v[120:121], v[120:121], v[186:187], v[186:187] op_sel:[0,0,1] op_sel_hi:[1,0,1]
    v_pk_fma_f32 v[122:123], v[122:123], v[186:187], v[186:187] op_sel:[0,0,1] op_sel_hi:[1,0,1]
    v_pk_fma_f32 v[124:125], v[124:125], v[186:187], v[186:187] op_sel:[0,0,1] op_sel_hi:[1,0,1]
    v_pk_fma_f32 v[126:127], v[126:127], v[186:187], v[186:187] op_sel:[0,0,1] op_sel_hi:[1,0,1]
    v_cvt_pk_bf16_f32 v40, v112, v113
    v_cvt_pk_bf16_f32 v41, v114, v115
    v_cvt_pk_bf16_f32 v42, v116, v117
    v_cvt_pk_bf16_f32 v43, v118, v119
    v_cvt_pk_bf16_f32 v44, v120, v121
    v_cvt_pk_bf16_f32 v45, v122, v123
    v_cvt_pk_bf16_f32 v46, v124, v125
    v_cvt_pk_bf16_f32 v47, v126, v127
    v_cvt_pk_bf16_f32 v32, v16, v17
    v_cvt_pk_bf16_f32 v33, v18, v19
    v_cvt_pk_bf16_f32 v34, v20, v21
    v_cvt_pk_bf16_f32 v35, v22, v23
    v_cvt_pk_bf16_f32 v36, v24, v25
    v_cvt_pk_bf16_f32 v37, v26, v27
    v_cvt_pk_bf16_f32 v38, v28, v29
    v_cvt_pk_bf16_f32 v39, v30, v31
    v_mfma_f32_32x32x16_bf16 v[48:63], v[32:35], v[40:43], 0
    s_nop 0
    v_mfma_f32_32x32x16_bf16 v[48:63], v[36:39], v[44:47], v[48:63]
    s_lshl_b32 s87, s42, 11
    s_add_u32 s87, s87, 114688
    s_xor_b32 s88, s87, 4096
    v_add_u32 v5, s87, v2
    v_add_u32 v6, s88, v2
    v_lshlrev_b32 v4, 5, v0
    s_mov_b32 s89, 9240576
    s_nop 0
    s_cmp_ge_u32 s42, 2
    s_cbranch_scc1 Lk5
    s_nop 1
    ds_write_b128 v6, v[56:59]
    ds_write_b128 v6, v[60:63] offset:1024
    s_waitcnt lgkmcnt(0)
    s_barrier
    ds_read_b128 v[56:59], v5
    ds_read_b128 v[60:63], v5 offset:1024
    s_branch Lk6
Lk5:
    s_nop 3
    ds_write_b128 v6, v[48:51]
    ds_write_b128 v6, v[52:55] offset:1024
    s_waitcnt lgkmcnt(0)
    s_barrier
    ds_read_b128 v[48:51], v5
    ds_read_b128 v[52:55], v5 offset:1024
Lk6:
    s_waitcnt lgkmcnt(1)
    v_pk_add_f32 v[48:49], v[48:49], v[56:57]
    v_pk_add_f32 v[50:51], v[50:51], v[58:59]
    s_waitcnt lgkmcnt(0)
    v_pk_add_f32 v[52:53], v[52:53], v[60:61]
    v_pk_add_f32 v[54:55], v[54:55], v[62:63]
    v_cvt_pk_bf16_f32 v56, v48, v49
    v_cvt_pk_bf16_f32 v57, v50, v51
    v_cvt_pk_bf16_f32 v58, v52, v53
    v_cvt_pk_bf16_f32 v59, v54, v55
    s_nop 0
    v_permlane32_swap_b32 v56, v58
    v_permlane32_swap_b32 v57, v59
    v_min_u32 v56, -2, v56
    v_min_u32 v57, -2, v57
    v_min_u32 v58, -2, v58
    v_min_u32 v59, -2, v59
    buffer_store_dwordx4 v[56:59], v79, s[36:39], s96 offen sc1
    v_lshlrev_b32 v4, 7, v0
    s_mov_b64 exec, 3
    global_load_dword v192, v4, s[40:41] sc1
    s_mov_b64 exec, -1
    s_cmp_ge_u32 s79, 28
    s_cbranch_scc1 Lhelp
    v_mov_b32 v80, -1
    v_mov_b32 v81, -1
    v_mov_b32 v82, -1
    v_mov_b32 v83, -1
    s_mul_i32 s87, s58, 28
    s_lshl_b32 s88, s44, 2
    s_add_u32 s87, s87, s88
    s_lshl_b32 s88, s76, 1
    s_add_u32 s87, s87, s88
    s_lshl_b32 s87, s87, 10
    s_add_u32 s100, s87, 2097152
    s_lshl_b32 s87, s58, 2
    s_lshr_b32 s88, s44, 1
    s_add_u32 s87, s87, s88
    s_lshl_b32 s87, s87, 9
    s_and_b32 s88, s44, 1
    s_lshl_b32 s88, s88, 3
    s_add_u32 s87, s87, s88
    s_add_u32 s101, s87, 8454144
    s_cmp_eq_u32 s76, 1
    s_cselect_b32 s101, 268435456, s101
    buffer_store_dwordx4 v[80:83], v2, s[36:39], s100 offen sc1
    buffer_store_dwordx4 v[80:83], v2, s[36:39], s100 offen offset:1024 sc1
    s_mov_b32 exec_hi, 0
    buffer_store_dwordx2 v[80:81], v2, s[36:39], s101 offen sc1
    s_mov_b64 exec, -1
    s_waitcnt vmcnt(5)
    s_barrier
    ds_read_b64_tr_b16 v[152:153], v94 offset:0
    ds_read_b64_tr_b16 v[154:155], v94 offset:512
    ds_read_b64_tr_b16 v[156:157], v94 offset:2048
    ds_read_b64_tr_b16 v[158:159], v94 offset:2560
    ds_read_b64_tr_b16 v[160:161], v94 offset:4096
    ds_read_b64_tr_b16 v[162:163], v94 offset:4608
    ds_read_b64_tr_b16 v[164:165], v94 offset:6144
    ds_read_b64_tr_b16 v[166:167], v94 offset:6656
    s_waitcnt lgkmcnt(6)
    v_mfma_f32_32x32x16_bf16 v[128:143], v[152:155], a[0:3], 0
    ds_read_b64_tr_b16 v[168:169], v94 offset:8192
    ds_read_b64_tr_b16 v[170:171], v94 offset:8704
    s_waitcnt lgkmcnt(6)
    v_mfma_f32_32x32x16_bf16 v[128:143], v[156:159], a[4:7], v[128:143]
    ds_read_b64_tr_b16 v[172:173], v94 offset:10240
    s_and_b32 s46, s2, 7
    ds_read_b64_tr_b16 v[174:175], v94 offset:10752
    s_xor_b32 s75, s58, 1
    s_waitcnt lgkmcnt(6)
    v_mfma_f32_32x32x16_bf16 v[128:143], v[160:163], a[8:11], v[128:143]
    s_and_b32 s78, s46, 6
    ds_read_b64_tr_b16 v[176:177], v94 offset:12288
    s_and_b32 s87, s79, 1
    ds_read_b64_tr_b16 v[178:179], v94 offset:12800
    s_add_u32 s78, s78, s87
    s_waitcnt lgkmcnt(6)
    v_mfma_f32_32x32x16_bf16 v[128:143], v[164:167], a[12:15], v[128:143]
    s_lshl2_add_u32 s78, s78, s42
    ds_read_b64_tr_b16 v[180:181], v94 offset:14336
    s_and_b32 s77, s46, 1
    ds_read_b64_tr_b16 v[182:183], v94 offset:14848
    s_mul_i32 s77, s77, 14
    s_waitcnt lgkmcnt(6)
    v_mfma_f32_32x32x16_bf16 v[128:143], v[168:171], a[16:19], v[128:143]
    s_lshr_b32 s88, s79, 1
    ds_read_b64_tr_b16 v[152:153], v94 offset:16384
    s_add_u32 s77, s77, s88
    ds_read_b64_tr_b16 v[154:155], v94 offset:16896
    s_lshl_b32 s3, s77, 11
    s_waitcnt lgkmcnt(6)
    v_mfma_f32_32x32x16_bf16 v[128:143], v[172:175], a[20:23], v[128:143]
    s_add_u32 s3, s3, 8781824
    ds_read_b64_tr_b16 v[156:157], v94 offset:18432
    s_mov_b32 s18, 0x62000
    ds_read_b64_tr_b16 v[158:159], v94 offset:18944
    s_mov_b32 s19, 0x20000
    s_waitcnt lgkmcnt(6)
    v_mfma_f32_32x32x16_bf16 v[128:143], v[176:179], a[24:27], v[128:143]
    s_mov_b32 s22, 0x188000
    ds_read_b64_tr_b16 v[160:161], v94 offset:20480
    s_mov_b32 s23, 0x20000
    ds_read_b64_tr_b16 v[162:163], v94 offset:20992
    s_mov_b32 s26, 0x188000
    s_waitcnt lgkmcnt(6)
    v_mfma_f32_32x32x16_bf16 v[128:143], v[180:183], a[28:31], v[128:143]
    s_mov_b32 s27, 0x20000
    ds_read_b64_tr_b16 v[164:165], v94 offset:22528
    s_mov_b32 s34, 0x1c0000
    ds_read_b64_tr_b16 v[166:167], v94 offset:23040
    s_mov_b32 s35, 0x20000
    s_waitcnt lgkmcnt(6)
    v_mfma_f32_32x32x16_bf16 v[128:143], v[152:155], a[32:35], v[128:143]
    s_and_b32 s87, s79, 1
    ds_read_b64_tr_b16 v[168:169], v94 offset:24576
    s_mul_i32 s87, s87, 3
    ds_read_b64_tr_b16 v[170:171], v94 offset:25088
    s_lshr_b32 s88, s79, 1
    s_waitcnt lgkmcnt(6)
    v_mfma_f32_32x32x16_bf16 v[128:143], v[156:159], a[36:39], v[128:143]
    ds_read_b64_tr_b16 v[172:173], v94 offset:26624
    s_add_u32 s87, s87, s88
    ds_read_b64_tr_b16 v[174:175], v94 offset:27136
    s_mul_i32 s88, s87, 37
    s_waitcnt lgkmcnt(6)
    v_mfma_f32_32x32x16_bf16 v[128:143], v[160:163], a[40:43], v[128:143]
    s_lshr_b32 s88, s88, 8
    ds_read_b64_tr_b16 v[176:177], v94 offset:28672
    s_mul_i32 s88, s88, 7
    ds_read_b64_tr_b16 v[178:179], v94 offset:29184
    s_sub_u32 s80, s87, s88
    s_waitcnt lgkmcnt(6)
    v_mfma_f32_32x32x16_bf16 v[128:143], v[164:167], a[44:47], v[128:143]
    s_add_u32 s81, s80, 1
    s_cmp_eq_u32 s81, 7
    s_cselect_b32 s81, 0, s81
    ds_read_b64_tr_b16 v[180:181], v94 offset:30720
    s_add_u32 s82, s81, 1
    s_cmp_eq_u32 s82, 7
    s_cselect_b32 s82, 0, s82
    ds_read_b64_tr_b16 v[182:183], v94 offset:31232
    s_add_u32 s83, s82, 1
    s_cmp_eq_u32 s83, 7
    s_cselect_b32 s83, 0, s83
    s_waitcnt lgkmcnt(6)
    v_mfma_f32_32x32x16_bf16 v[128:143], v[168:171], a[48:51], v[128:143]
    s_add_u32 s84, s83, 1
    s_cmp_eq_u32 s84, 7
    s_cselect_b32 s84, 0, s84
    ds_read_b64_tr_b16 v[152:153], v94 offset:32768
    s_add_u32 s85, s84, 1
    s_cmp_eq_u32 s85, 7
    s_cselect_b32 s85, 0, s85
    ds_read_b64_tr_b16 v[154:155], v94 offset:33280
    s_add_u32 s86, s85, 1
    s_cmp_eq_u32 s86, 7
    s_cselect_b32 s86, 0, s86
    s_waitcnt lgkmcnt(6)
    v_mfma_f32_32x32x16_bf16 v[128:143], v[172:175], a[52:55], v[128:143]
    v_bfe_u32 v4, v0, 4, 1
    ds_read_b64_tr_b16 v[156:157], v94 offset:34816
    v_bfe_u32 v5, v0, 1, 1
    ds_read_b64_tr_b16 v[158:159], v94 offset:35328
    v_lshl_add_u32 v5, v4, 1, v5
    s_waitcnt lgkmcnt(6)
    v_mfma_f32_32x32x16_bf16 v[128:143], v[176:179], a[56:59], v[128:143]
    v_bfe_u32 v4, v0, 3, 1
    ds_read_b64_tr_b16 v[160:161], v94 offset:36864
    v_xor_b32 v4, s76, v4
    ds_read_b64_tr_b16 v[162:163], v94 offset:37376
    v_lshl_add_u32 v5, v4, 2, v5
    s_waitcnt lgkmcnt(6)
    v_mfma_f32_32x32x16_bf16 v[128:143], v[180:183], a[60:63], v[128:143]
    v_lshlrev_b32 v5, 4, v5
    ds_read_b64_tr_b16 v[164:165], v94 offset:38912
    v_and_b32 v4, 1, v0
    ds_read_b64_tr_b16 v[166:167], v94 offset:39424
    v_lshl_add_u32 v5, v4, 3, v5
    s_waitcnt lgkmcnt(6)
    v_mfma_f32_32x32x16_bf16 v[128:143], v[152:155], a[64:67], v[128:143]
    v_bfe_u32 v4, v0, 2, 2
    ds_read_b64_tr_b16 v[168:169], v94 offset:40960
    v_lshrrev_b32 v6, 5, v0
    ds_read_b64_tr_b16 v[170:171], v94 offset:41472
    v_lshl_add_u32 v4, v6, 2, v4
    s_waitcnt lgkmcnt(6)
    v_mfma_f32_32x32x16_bf16 v[128:143], v[156:159], a[68:71], v[128:143]
    ds_read_b64_tr_b16 v[172:173], v94 offset:43008
    v_lshl_add_u32 v252, v4, 7, v5
    ds_read_b64_tr_b16 v[174:175], v94 offset:43520
    v_xor_b32 v253, 64, v252
    s_waitcnt lgkmcnt(6)
    v_mfma_f32_32x32x16_bf16 v[128:143], v[160:163], a[72:75], v[128:143]
    s_mul_i32 s87, s42, 14336
    ds_read_b64_tr_b16 v[176:177], v94 offset:45056
    s_add_u32 s87, s87, 57344
    ds_read_b64_tr_b16 v[178:179], v94 offset:45568
    v_add_u32 v244, s87, v252
    s_waitcnt lgkmcnt(6)
    v_mfma_f32_32x32x16_bf16 v[128:143], v[164:167], a[76:79], v[128:143]
    v_add_u32 v245, s87, v253
    ds_read_b64_tr_b16 v[180:181], v94 offset:47104
    v_lshrrev_b32 v4, 3, v0
    ds_read_b64_tr_b16 v[182:183], v94 offset:47616
    v_mul_u32_u24 v4, 3584, v4
    s_waitcnt lgkmcnt(6)
    v_mfma_f32_32x32x16_bf16 v[128:143], v[168:171], a[80:83], v[128:143]
    v_bfe_u32 v5, v0, 1, 2
    ds_read_b64_tr_b16 v[152:153], v94 offset:49152
    v_bfe_u32 v6, v0, 4, 1
    ds_read_b64_tr_b16 v[154:155], v94 offset:49664
    v_xor_b32 v5, v5, v6
    s_waitcnt lgkmcnt(6)
    v_mfma_f32_32x32x16_bf16 v[128:143], v[172:175], a[84:87], v[128:143]
    v_and_b32 v6, 1, v0
    ds_read_b64_tr_b16 v[156:157], v94 offset:51200
    v_lshl_add_u32 v4, v6, 4, v4
    ds_read_b64_tr_b16 v[158:159], v94 offset:51712
    s_lshl_b32 s87, s77, 7
    s_waitcnt lgkmcnt(6)
    v_mfma_f32_32x32x16_bf16 v[128:143], v[176:179], a[88:91], v[128:143]
    v_add_u32 v4, s87, v4
    ds_read_b64_tr_b16 v[160:161], v94 offset:53248
    v_lshl_add_u32 v248, v5, 5, v4
    ds_read_b64_tr_b16 v[162:163], v94 offset:53760
    v_xor_b32 v5, 2, v5
    s_waitcnt lgkmcnt(6)
    v_mfma_f32_32x32x16_bf16 v[128:143], v[180:183], a[92:95], v[128:143]
    v_lshl_add_u32 v249, v5, 5, v4
    ds_read_b64_tr_b16 v[164:165], v94 offset:55296
    s_mul_i32 s53, s42, 28672
    ds_read_b64_tr_b16 v[166:167], v94 offset:55808
    s_mul_i32 s90, s42, 100352
    s_waitcnt lgkmcnt(6)
    v_mfma_f32_32x32x16_bf16 v[128:143], v[152:155], a[96:99], v[128:143]
    s_lshl_b32 s87, s44, 7
    s_waitcnt lgkmcnt(4)
    v_mfma_f32_32x32x16_bf16 v[128:143], v[156:159], a[100:103], v[128:143]
    s_add_u32 s90, s90, s87
    s_waitcnt lgkmcnt(2)
    v_mfma_f32_32x32x16_bf16 v[128:143], v[160:163], a[104:107], v[128:143]
    s_mul_i32 s96, s42, 14336
    s_waitcnt lgkmcnt(0)
    v_mfma_f32_32x32x16_bf16 v[128:143], v[164:167], a[108:111], v[128:143]
    s_add_u32 s96, s96, 57344
    s_cmp_lg_u32 s42, 0
    s_cbranch_scc1 Lq7
    s_waitcnt vmcnt(3)
    v_readlane_b32 s87, v192, 0
    v_readlane_b32 s88, v192, 1
    s_nop 3
    s_add_u32 s87, s87, s88
    s_cmp_lt_u32 s87, 256
    s_cselect_b64 vcc, -1, 0
    s_cbranch_vccnz Lini8_slow
Lini8:
    s_lshl_b32 s89, s44, 5
    s_add_u32 s89, s89, s43
    s_lshl_b32 s89, s89, 12
    s_add_u32 s89, s89, 4194304
    buffer_load_dwordx4 v[200:203], v2, s[36:39], s89 offen offset:0 sc1
    buffer_load_dwordx4 v[204:207], v2, s[36:39], s89 offen offset:1024 sc1
    buffer_load_dwordx4 v[208:211], v2, s[36:39], s89 offen offset:2048 sc1
    buffer_load_dwordx4 v[212:215], v2, s[36:39], s89 offen offset:3072 sc1
Lq7:
    v_pk_mul_f32 v[16:17], v[128:129], s[70:71] op_sel:[0,1]
    v_pk_mul_f32 v[18:19], v[130:131], s[70:71] op_sel:[0,1]
    v_pk_mul_f32 v[20:21], v[132:133], s[70:71] op_sel:[0,1]
    v_pk_mul_f32 v[22:23], v[134:135], s[70:71] op_sel:[0,1]
    v_pk_mul_f32 v[24:25], v[136:137], s[70:71] op_sel:[0,1]
    v_pk_mul_f32 v[26:27], v[138:139], s[70:71] op_sel:[0,1]
    v_pk_mul_f32 v[28:29], v[140:141], s[70:71] op_sel:[0,1]
    v_pk_mul_f32 v[30:31], v[142:143], s[70:71] op_sel:[0,1]
    v_exp_f32_e64 v16, v16 clamp
    v_max_f32 v128, 0, v128
    v_exp_f32_e64 v17, v17 clamp
    v_max_f32 v129, 0, v129
    v_exp_f32_e64 v18, v18 clamp
    v_max_f32 v130, 0, v130
    v_exp_f32_e64 v19, v19 clamp
    v_max_f32 v131, 0, v131
    v_exp_f32_e64 v20, v20 clamp
    v_max_f32 v132, 0, v132
    v_exp_f32_e64 v21, v21 clamp
    v_max_f32 v133, 0, v133
    v_exp_f32_e64 v22, v22 clamp
    v_max_f32 v134, 0, v134
    v_exp_f32_e64 v23, v23 clamp
    v_max_f32 v135, 0, v135
    v_exp_f32_e64 v24, v24 clamp
    v_max_f32 v136, 0, v136
    v_exp_f32_e64 v25, v25 clamp
    v_max_f32 v137, 0, v137
    v_exp_f32_e64 v26, v26 clamp
    v_max_f32 v138, 0, v138
    v_exp_f32_e64 v27, v27 clamp
    v_max_f32 v139, 0, v139
    v_exp_f32_e64 v28, v28 clamp
    v_max_f32 v140, 0, v140
    v_exp_f32_e64 v29, v29 clamp
    v_max_f32 v141, 0, v141
    v_exp_f32_e64 v30, v30 clamp
    v_max_f32 v142, 0, v142
    v_exp_f32_e64 v31, v31 clamp
    v_max_f32 v143, 0, v143
    v_pk_add_f32 v[16:17], v[16:17], v[128:129]
    v_pk_add_f32 v[18:19], v[18:19], v[130:131]
    v_pk_add_f32 v[20:21], v[20:21], v[132:133]
    v_pk_add_f32 v[22:23], v[22:23], v[134:135]
    v_pk_add_f32 v[24:25], v[24:25], v[136:137]
    v_pk_add_f32 v[26:27], v[26:27], v[138:139]
    v_pk_add_f32 v[28:29], v[28:29], v[140:141]
    v_pk_add_f32 v[30:31], v[30:31], v[142:143]
    v_mov_b32 v4, 0x358637bd
    v_pk_add_f32 v[16:17], v[16:17], v[4:5] op_sel_hi:[1,0]
    v_pk_add_f32 v[18:19], v[18:19], v[4:5] op_sel_hi:[1,0]
    v_pk_add_f32 v[20:21], v[20:21], v[4:5] op_sel_hi:[1,0]
    v_pk_add_f32 v[22:23], v[22:23], v[4:5] op_sel_hi:[1,0]
    v_pk_add_f32 v[24:25], v[24:25], v[4:5] op_sel_hi:[1,0]
    v_pk_add_f32 v[26:27], v[26:27], v[4:5] op_sel_hi:[1,0]
    v_pk_add_f32 v[28:29], v[28:29], v[4:5] op_sel_hi:[1,0]
    v_pk_add_f32 v[30:31], v[30:31], v[4:5] op_sel_hi:[1,0]
    v_cvt_pk_bf16_f32 v32, v16, v17
    v_cvt_pk_bf16_f32 v33, v18, v19
    v_cvt_pk_bf16_f32 v34, v20, v21
    v_cvt_pk_bf16_f32 v35, v22, v23
    v_cvt_pk_bf16_f32 v36, v24, v25
    v_cvt_pk_bf16_f32 v37, v26, v27
    v_cvt_pk_bf16_f32 v38, v28, v29
    v_cvt_pk_bf16_f32 v39, v30, v31
    s_mul_i32 s87, s58, 56
    s_lshl_b32 s88, s44, 3
    s_add_u32 s87, s87, s88
    s_lshl_b32 s88, s76, 2
    s_add_u32 s87, s87, s88
    s_lshl_b32 s87, s87, 9
    s_add_u32 s87, s87, 0
    v_permlane32_swap_b32 v32, v34
    v_permlane32_swap_b32 v33, v35
    v_permlane32_swap_b32 v36, v38
    v_permlane32_swap_b32 v37, v39
    buffer_store_dwordx4 v[32:35], v2, s[36:39], s87 offen sc1
    buffer_store_dwordx4 v[36:39], v2, s[36:39], s87 offen offset:1024 sc1
    s_waitcnt vmcnt(2)
    s_barrier
    s_cmp_eq_u32 s42, 0
    s_cbranch_scc1 Lw09
    s_waitcnt vmcnt(0)
    s_lshl_b32 s73, s43, 10
    s_add_u32 s73, s73, 8912896
    s_mov_b32 s45, 1
    s_atomic_add s45, s[36:37], s73
    s_barrier
    v_lshrrev_b32 v4, 2, v0
    v_mul_u32_u24 v4, 896, v4
    v_and_b32 v5, 3, v0
    v_lshl_add_u32 v250, v5, 4, v4
    s_mul_i32 s87, s58, 28672
    s_lshl_b32 s88, s44, 7
    s_add_u32 s87, s87, s88
    s_lshl_b32 s88, s76, 6
    s_add_u32 s87, s87, s88
    s_lshl_b32 s88, s42, 11
    s_add_u32 m0, s88, 49152
    s_nop 0
    buffer_load_dwordx4 v250, s[8:11], s87 offen lds
    s_add_u32 m0, s88, 50176
    s_add_u32 s87, s87, 14336
    buffer_load_dwordx4 v250, s[8:11], s87 offen lds
    s_add_u32 s47, s90, 0
    s_add_u32 m0, s96, 0
    s_nop 0
    buffer_load_dwordx4 v14, s[16:19], s47 offen  lds
    s_add_u32 s47, s90, 7168
    s_add_u32 m0, s96, 1024
    s_nop 0
    buffer_load_dwordx4 v14, s[16:19], s47 offen  lds
    s_add_u32 s47, s90, 14336
    s_add_u32 m0, s96, 2048
    s_nop 0
    buffer_load_dwordx4 v14, s[16:19], s47 offen  lds
    s_add_u32 s47, s90, 21504
    s_add_u32 m0, s96, 3072
    s_nop 0
    buffer_load_dwordx4 v14, s[16:19], s47 offen  lds
    s_add_u32 s47, s90, 28672
    s_add_u32 m0, s96, 4096
    s_nop 0
    buffer_load_dwordx4 v14, s[16:19], s47 offen  lds
    s_add_u32 s47, s90, 35840
    s_add_u32 m0, s96, 5120
    s_nop 0
    buffer_load_dwordx4 v14, s[16:19], s47 offen  lds
    s_add_u32 s47, s90, 43008
    s_add_u32 m0, s96, 6144
    s_nop 0
    buffer_load_dwordx4 v14, s[16:19], s47 offen  lds
    s_add_u32 s47, s90, 50176
    s_add_u32 m0, s96, 7168
    s_nop 0
    buffer_load_dwordx4 v14, s[16:19], s47 offen  lds
    s_add_u32 s47, s90, 57344
    s_add_u32 m0, s96, 8192
    s_nop 0
    buffer_load_dwordx4 v14, s[16:19], s47 offen  lds
    s_add_u32 s47, s90, 64512
    s_add_u32 m0, s96, 9216
    s_nop 0
    buffer_load_dwordx4 v14, s[16:19], s47 offen  lds
    s_add_u32 s47, s90, 71680
    s_add_u32 m0, s96, 10240
    s_nop 0
    buffer_load_dwordx4 v14, s[16:19], s47 offen  lds
    s_add_u32 s47, s90, 78848
    s_add_u32 m0, s96, 11264
    s_nop 0
    buffer_load_dwordx4 v14, s[16:19], s47 offen  lds
    s_add_u32 s47, s90, 86016
    s_add_u32 m0, s96, 12288
    s_nop 0
    buffer_load_dwordx4 v14, s[16:19], s47 offen  lds
    s_add_u32 s47, s90, 93184
    s_add_u32 m0, s96, 13312
    s_nop 0
    buffer_load_dwordx4 v14, s[16:19], s47 offen  lds
    s_sub_u32 s89, s42, 1
    s_branch Ljn10
Lw09:
    s_mov_b32 s93, 0
    v_max3_u32 v4, v200, v201, v202
    v_max3_u32 v5, v203, v204, v205
    v_max3_u32 v4, v4, v206, v207
    v_max3_u32 v5, v5, v208, v209
    v_max3_u32 v4, v4, v210, v211
    v_max3_u32 v5, v5, v212, v213
    v_max3_u32 v4, v4, v214, v215
    v_max_u32 v4, v4, v5
    v_cmp_eq_u32 vcc, -1, v4
    s_nop 3
    s_cbranch_vccnz Lri11_slow
Lri11:
    v_dot2_f32_bf16 v168, v200, s91, 0
    v_dot2_f32_bf16 v169, v200, s92, 0
    v_dot2_f32_bf16 v170, v201, s91, 0
    v_dot2_f32_bf16 v171, v201, s92, 0
    v_dot2_f32_bf16 v172, v202, s91, 0
    v_dot2_f32_bf16 v173, v202, s92, 0
    v_dot2_f32_bf16 v174, v203, s91, 0
    v_dot2_f32_bf16 v175, v203, s92, 0
    v_dot2_f32_bf16 v168, v204, s91, v168
    v_dot2_f32_bf16 v169, v204, s92, v169
    v_dot2_f32_bf16 v170, v205, s91, v170
    v_dot2_f32_bf16 v171, v205, s92, v171
    v_dot2_f32_bf16 v172, v206, s91, v172
    v_dot2_f32_bf16 v173, v206, s92, v173
    v_dot2_f32_bf16 v174, v207, s91, v174
    v_dot2_f32_bf16 v175, v207, s92, v175
    v_dot2_f32_bf16 v168, v208, s91, v168
    v_dot2_f32_bf16 v169, v208, s92, v169
    v_dot2_f32_bf16 v170, v209, s91, v170
    v_dot2_f32_bf16 v171, v209, s92, v171
    v_dot2_f32_bf16 v172, v210, s91, v172
    v_dot2_f32_bf16 v173, v210, s92, v173
    v_dot2_f32_bf16 v174, v211, s91, v174
    v_dot2_f32_bf16 v175, v211, s92, v175
    v_dot2_f32_bf16 v168, v212, s91, v168
    v_dot2_f32_bf16 v169, v212, s92, v169
    v_dot2_f32_bf16 v170, v213, s91, v170
    v_dot2_f32_bf16 v171, v213, s92, v171
    v_dot2_f32_bf16 v172, v214, s91, v172
    v_dot2_f32_bf16 v173, v214, s92, v173
    v_dot2_f32_bf16 v174, v215, s91, v174
    v_dot2_f32_bf16 v175, v215, s92, v175
    v_add_f32_dpp v168, v168, v168 row_ror:8 row_mask:0xf bank_mask:0xf
    v_add_f32_dpp v169, v169, v169 row_ror:8 row_mask:0xf bank_mask:0xf
    v_add_f32_dpp v170, v170, v170 row_ror:8 row_mask:0xf bank_mask:0xf
    v_add_f32_dpp v171, v171, v171 row_ror:8 row_mask:0xf bank_mask:0xf
    v_add_f32_dpp v172, v172, v172 row_ror:8 row_mask:0xf bank_mask:0xf
    v_add_f32_dpp v173, v173, v173 row_ror:8 row_mask:0xf bank_mask:0xf
    v_add_f32_dpp v174, v174, v174 row_ror:8 row_mask:0xf bank_mask:0xf
    v_add_f32_dpp v175, v175, v175 row_ror:8 row_mask:0xf bank_mask:0xf
    v_mov_b64 v[176:177], v[168:169]
    v_mov_b64 v[178:179], v[170:171]
    v_mov_b64 v[180:181], v[172:173]
    v_mov_b64 v[182:183], v[174:175]
    v_permlane16_swap_b32 v168, v176
    v_permlane16_swap_b32 v169, v177
    v_permlane16_swap_b32 v170, v178
    v_permlane16_swap_b32 v171, v179
    v_permlane16_swap_b32 v172, v180
    v_permlane16_swap_b32 v173, v181
    v_permlane16_swap_b32 v174, v182
    v_permlane16_swap_b32 v175, v183
    v_pk_add_f32 v[168:169], v[168:169], v[176:177]
    v_pk_add_f32 v[170:171], v[170:171], v[178:179]
    v_pk_add_f32 v[172:173], v[172:173], v[180:181]
    v_pk_add_f32 v[174:175], v[174:175], v[182:183]
    v_mov_b64 v[176:177], v[168:169]
    v_mov_b64 v[178:179], v[170:171]
    v_mov_b64 v[180:181], v[172:173]
    v_mov_b64 v[182:183], v[174:175]
    v_permlane32_swap_b32 v168, v176
    v_permlane32_swap_b32 v169, v177
    v_permlane32_swap_b32 v170, v178
    v_permlane32_swap_b32 v171, v179
    v_permlane32_swap_b32 v172, v180
    v_permlane32_swap_b32 v173, v181
    v_permlane32_swap_b32 v174, v182
    v_permlane32_swap_b32 v175, v183
    v_pk_add_f32 v[168:169], v[168:169], v[176:177]
    v_pk_add_f32 v[170:171], v[170:171], v[178:179]
    v_pk_add_f32 v[172:173], v[172:173], v[180:181]
    v_pk_add_f32 v[174:175], v[174:175], v[182:183]
    v_cvt_pk_bf16_f32 v4, v168, v169
    v_cvt_pk_bf16_f32 v5, v170, v171
    v_cvt_pk_bf16_f32 v6, v172, v173
    v_cvt_pk_bf16_f32 v7, v174, v175
    v_min_u32 v4, -2, v4
    v_min_u32 v5, -2, v5
    v_min_u32 v6, -2, v6
    v_min_u32 v7, -2, v7
    s_mov_b64 exec, 0xff
    buffer_store_dwordx4 v[4:7], v2, s[36:39], s97 offen sc1
    s_mov_b64 exec, -1
    s_cmp_lg_u32 s93, 0
    s_cbranch_scc1 Lpqdone
    s_waitcnt vmcnt(1)
    s_lshl_b32 s73, s43, 10
    s_add_u32 s73, s73, 8912896
    s_mov_b32 s45, 1
    s_atomic_add s45, s[36:37], s73
Lpqdone:
    s_barrier
    v_lshrrev_b32 v4, 2, v0
    v_mul_u32_u24 v4, 896, v4
    v_and_b32 v5, 3, v0
    v_lshl_add_u32 v250, v5, 4, v4
    s_mul_i32 s87, s58, 28672
    s_lshl_b32 s88, s44, 7
    s_add_u32 s87, s87, s88
    s_lshl_b32 s88, s76, 6
    s_add_u32 s87, s87, s88
    s_lshl_b32 s88, s42, 11
    s_add_u32 m0, s88, 49152
    s_nop 0
    buffer_load_dwordx4 v250, s[8:11], s87 offen lds
    s_add_u32 m0, s88, 50176
    s_add_u32 s87, s87, 14336
    buffer_load_dwordx4 v250, s[8:11], s87 offen lds
    s_add_u32 s47, s90, 0
    s_add_u32 m0, s96, 0
    s_nop 0
    buffer_load_dwordx4 v14, s[16:19], s47 offen  lds
    s_add_u32 s47, s90, 7168
    s_add_u32 m0, s96, 1024
    s_nop 0
    buffer_load_dwordx4 v14, s[16:19], s47 offen  lds
    s_add_u32 s47, s90, 14336
    s_add_u32 m0, s96, 2048
    s_nop 0
    buffer_load_dwordx4 v14, s[16:19], s47 offen  lds
    s_add_u32 s47, s90, 21504
    s_add_u32 m0, s96, 3072
    s_nop 0
    buffer_load_dwordx4 v14, s[16:19], s47 offen  lds
    s_add_u32 s47, s90, 28672
    s_add_u32 m0, s96, 4096
    s_nop 0
    buffer_load_dwordx4 v14, s[16:19], s47 offen  lds
    s_add_u32 s47, s90, 35840
    s_add_u32 m0, s96, 5120
    s_nop 0
    buffer_load_dwordx4 v14, s[16:19], s47 offen  lds
    s_add_u32 s47, s90, 43008
    s_add_u32 m0, s96, 6144
    s_nop 0
    buffer_load_dwordx4 v14, s[16:19], s47 offen  lds
    s_add_u32 s47, s90, 50176
    s_add_u32 m0, s96, 7168
    s_nop 0
    buffer_load_dwordx4 v14, s[16:19], s47 offen  lds
    s_add_u32 s47, s90, 57344
    s_add_u32 m0, s96, 8192
    s_nop 0
    buffer_load_dwordx4 v14, s[16:19], s47 offen  lds
    s_add_u32 s47, s90, 64512
    s_add_u32 m0, s96, 9216
    s_nop 0
    buffer_load_dwordx4 v14, s[16:19], s47 offen  lds
    s_add_u32 s47, s90, 71680
    s_add_u32 m0, s96, 10240
    s_nop 0
    buffer_load_dwordx4 v14, s[16:19], s47 offen  lds
    s_add_u32 s47, s90, 78848
    s_add_u32 m0, s96, 11264
    s_nop 0
    buffer_load_dwordx4 v14, s[16:19], s47 offen  lds
    s_add_u32 s47, s90, 86016
    s_add_u32 m0, s96, 12288
    s_nop 0
    buffer_load_dwordx4 v14, s[16:19], s47 offen  lds
    s_add_u32 s47, s90, 93184
    s_add_u32 m0, s96, 13312
    s_nop 0
    buffer_load_dwordx4 v14, s[16:19], s47 offen  lds
Ljn10:
    s_cmp_lg_u32 s42, 1
    s_cbranch_scc1 Lx312
    s_load_dword s72, s[36:37], s73 glc
    s_waitcnt lgkmcnt(0)
    s_cmp_lt_u32 s72, 28
    s_cbranch_scc1 Lsc13_slow
Lsc13:
Lx312:
    s_barrier
    s_lshl_b32 s46, s42, 13
    s_add_u32 s46, s46, 8388608
    s_add_u32 s47, s46, 4096
    buffer_load_dwordx4 v[200:203], v2, s[36:39], s46 offen offset:0 sc1
    buffer_load_dwordx4 v[204:207], v2, s[36:39], s46 offen offset:1024 sc1
    buffer_load_dwordx4 v[208:211], v2, s[36:39], s46 offen offset:2048 sc1
    buffer_load_dwordx4 v[212:215], v2, s[36:39], s46 offen offset:3072 sc1
    buffer_load_dwordx4 v[216:219], v2, s[36:39], s47 offen offset:0 sc1
    buffer_load_dwordx4 v[220:223], v2, s[36:39], s47 offen offset:1024 sc1
    buffer_load_dwordx4 v[224:227], v2, s[36:39], s47 offen offset:2048 sc1
    buffer_load_dwordx4 v[228:231], v2, s[36:39], s47 offen offset:3072 sc1
    s_mul_i32 s87, s75, 56
    s_mul_i32 s88, s42, 14
    s_add_u32 s87, s87, s88
    s_lshl_b32 s87, s87, 9
    s_add_u32 s87, s87, 0
    s_add_u32 s88, s87, 3584
    buffer_load_dwordx4 a[208:211], v2, s[36:39], s87 offen offset:0 sc1
    buffer_load_dwordx4 a[212:215], v2, s[36:39], s87 offen offset:1024 sc1
    buffer_load_dwordx4 a[216:219], v2, s[36:39], s87 offen offset:1536 sc1
    buffer_load_dwordx4 a[220:223], v2, s[36:39], s87 offen offset:2560 sc1
    s_waitcnt vmcnt(12)
    ds_read_b64_tr_b16 a[112:113], v244 offset:0
    ds_read_b64_tr_b16 a[114:115], v244 offset:1024
    ds_read_b64_tr_b16 a[116:117], v245 offset:0
    ds_read_b64_tr_b16 a[118:119], v245 offset:1024
    ds_read_b64_tr_b16 a[120:121], v244 offset:2048
    ds_read_b64_tr_b16 a[122:123], v244 offset:3072
    ds_read_b64_tr_b16 a[124:125], v245 offset:2048
    ds_read_b64_tr_b16 a[126:127], v245 offset:3072
    ds_read_b64_tr_b16 a[128:129], v244 offset:3072
    ds_read_b64_tr_b16 a[130:131], v244 offset:4096
    ds_read_b64_tr_b16 a[132:133], v245 offset:3072
    ds_read_b64_tr_b16 a[134:135], v245 offset:4096
    ds_read_b64_tr_b16 a[136:137], v244 offset:5120
    ds_read_b64_tr_b16 a[138:139], v244 offset:6144
    ds_read_b64_tr_b16 a[140:141], v245 offset:5120
    ds_read_b64_tr_b16 a[142:143], v245 offset:6144
    ds_read_b64_tr_b16 a[144:145], v244 offset:7168
    ds_read_b64_tr_b16 a[146:147], v244 offset:8192
    ds_read_b64_tr_b16 a[148:149], v245 offset:7168
    ds_read_b64_tr_b16 a[150:151], v245 offset:8192
    ds_read_b64_tr_b16 a[152:153], v244 offset:9216
    ds_read_b64_tr_b16 a[154:155], v244 offset:10240
    ds_read_b64_tr_b16 a[156:157], v245 offset:9216
    ds_read_b64_tr_b16 a[158:159], v245 offset:10240
    ds_read_b64_tr_b16 a[160:161], v244 offset:10240
    ds_read_b64_tr_b16 a[162:163], v244 offset:11264
    ds_read_b64_tr_b16 a[164:165], v245 offset:10240
    ds_read_b64_tr_b16 a[166:167], v245 offset:11264
    ds_read_b64_tr_b16 a[168:169], v244 offset:12288
    ds_read_b64_tr_b16 a[170:171], v244 offset:13312
    ds_read_b64_tr_b16 a[172:173], v245 offset:12288
    ds_read_b64_tr_b16 a[174:175], v245 offset:13312
    s_mul_i32 s90, s42, 28672
    v_and_b32 v4, 31, v0
    v_lshlrev_b32 v4, 6, v4
    v_lshrrev_b32 v5, 5, v0
    v_lshl_add_u32 v4, v5, 3, v4
    s_lshl_b32 s89, s42, 11
    s_add_u32 s89, s89, 49152
    v_add_u32 v251, s89, v4
    v_cmp_gt_u32 vcc, 32, v0
    v_mov_b32 v4, 1.0
    s_nop 0
    v_cndmask_b32 v246, 0, v4, vcc
    v_sub_f32 v247, 1.0, v246
    s_xor_b32 s49, s42, 1
    s_mul_i32 s49, s49, 12288
    s_add_u32 s49, s49, 0
    v_add_u32 v64, s49, v2
    s_xor_b32 s49, s42, 2
    s_mul_i32 s49, s49, 12288
    s_add_u32 s49, s49, 4096
    v_add_u32 v65, s49, v2
    s_xor_b32 s49, s42, 3
    s_mul_i32 s49, s49, 12288
    s_add_u32 s49, s49, 8192
    v_add_u32 v66, s49, v2
    s_mul_i32 s49, s42, 12288
    v_add_u32 v67, s49, v2
    ds_read_b64 v[232:233], v251 offset:0
    ds_read_b64 v[234:235], v251 offset:16
    ds_read_b64 v[236:237], v251 offset:32
    ds_read_b64 v[238:239], v251 offset:48
    s_waitcnt vmcnt(11)
    v_max3_u32 v4, v200, v201, v202
    s_waitcnt vmcnt(10)
    v_max3_u32 v5, v203, v204, v205
    v_max3_u32 v4, v4, v206, v207
    s_waitcnt vmcnt(9)
    v_max3_u32 v5, v5, v208, v209
    v_max3_u32 v4, v4, v210, v211
    s_waitcnt vmcnt(8)
    v_max3_u32 v5, v5, v212, v213
    v_max3_u32 v4, v4, v214, v215
    s_waitcnt vmcnt(7)
    v_max3_u32 v5, v5, v216, v217
    v_max3_u32 v4, v4, v218, v219
    s_waitcnt vmcnt(6)
    v_max3_u32 v5, v5, v220, v221
    v_max3_u32 v4, v4, v222, v223
    s_waitcnt vmcnt(5)
    v_max3_u32 v5, v5, v224, v225
    v_max3_u32 v4, v4, v226, v227
    s_waitcnt vmcnt(4)
    v_max3_u32 v5, v5, v228, v229
    v_max3_u32 v4, v4, v230, v231
    v_max_u32 v4, v4, v5
    v_cmp_eq_u32 vcc, -1, v4
    s_nop 3
    s_cbranch_vccnz Lkvslow
Lkvok:
    buffer_load_dwordx4 a[224:227], v2, s[36:39], s88 offen offset:0 sc1
    buffer_load_dwordx4 a[228:231], v2, s[36:39], s88 offen offset:1024 sc1
    buffer_load_dwordx4 a[232:235], v2, s[36:39], s88 offen offset:1536 sc1
    buffer_load_dwordx4 a[236:239], v2, s[36:39], s88 offen offset:2560 sc1
    s_mul_i32 s87, s58, 56
    s_mul_i32 s88, s42, 14
    s_add_u32 s87, s87, s88
    s_lshl_b32 s87, s87, 9
    s_add_u32 s87, s87, 0
    s_add_u32 s88, s87, 3584
    buffer_load_dwordx4 a[176:179], v2, s[36:39], s87 offen offset:0 sc1
    buffer_load_dwordx4 a[180:183], v2, s[36:39], s87 offen offset:1024 sc1
    buffer_load_dwordx4 a[184:187], v2, s[36:39], s87 offen offset:1536 sc1
    buffer_load_dwordx4 a[188:191], v2, s[36:39], s87 offen offset:2560 sc1
    buffer_load_dwordx4 a[192:195], v2, s[36:39], s88 offen offset:0 sc1
    buffer_load_dwordx4 a[196:199], v2, s[36:39], s88 offen offset:1024 sc1
    buffer_load_dwordx4 a[200:203], v2, s[36:39], s88 offen offset:1536 sc1
    buffer_load_dwordx4 a[204:207], v2, s[36:39], s88 offen offset:2560 sc1
    s_waitcnt vmcnt(15)
    v_mfma_f32_32x32x16_bf16 v[152:167], v[200:203], a[208:211], 0
    s_waitcnt vmcnt(14)
    v_mfma_f32_32x32x16_bf16 v[152:167], v[204:207], a[212:215], v[152:167]
    s_waitcnt vmcnt(13)
    v_mfma_f32_32x32x16_bf16 v[168:183], v[208:211], a[216:219], 0
    s_waitcnt vmcnt(12)
    v_mfma_f32_32x32x16_bf16 v[168:183], v[212:215], a[220:223], v[168:183]
    s_waitcnt lgkmcnt(0)
    s_barrier
    s_nop 5
    v_mov_b32 v32, v164
    v_mov_b32 v33, v164
    s_nop 1
    v_permlane32_swap_b32 v32, v33
    v_add_f32 v35, 0x358637bd, v33
    v_rcp_f32 v35, v35
    s_nop 0
    v_mul_f32 v34, v35, v246
    s_waitcnt vmcnt(11)
    v_mfma_f32_32x32x16_bf16 v[16:31], v[216:219], a[224:227], 0
    v_mul_f32 v152, v35, v152
    v_mul_f32 v153, v35, v153
    v_mul_f32 v154, v35, v154
    v_mul_f32 v155, v35, v155
    v_mul_f32 v156, v35, v156
    v_mul_f32 v157, v35, v157
    s_waitcnt vmcnt(10)
    v_mfma_f32_32x32x16_bf16 v[16:31], v[220:223], a[228:231], v[16:31]
    v_mul_f32 v158, v35, v158
    v_mul_f32 v159, v35, v159
    v_cvt_pk_bf16_f32 v184, v152, v153
    v_cvt_pk_bf16_f32 v185, v154, v155
    v_cvt_pk_bf16_f32 v186, v156, v157
    v_cvt_pk_bf16_f32 v187, v158, v159
    s_mul_i32 s47, s81, 229376
    s_add_u32 s47, s47, s53
    s_add_u32 s47, s47, 0
    s_add_u32 m0, s57, 114688
    s_nop 0
    buffer_load_dwordx4 v249, s[24:27], s47 offen  lds
    v_mul_f32 v160, v35, v160
    v_mul_f32 v161, v35, v161
    v_mov_b32 v36, v168
    v_mul_f32 v162, v35, v162
    v_mul_f32 v163, v35, v163
    v_mov_b32 v37, v168
    v_mul_f32 v164, v34, v164
    v_mul_f32 v165, v35, v165
    v_permlane32_swap_b32 v36, v37
    v_mul_f32 v166, v35, v166
    v_mul_f32 v167, v35, v167
    v_add_f32 v39, 0x358637bd, v36
    v_cvt_pk_bf16_f32 v188, v160, v161
    v_cvt_pk_bf16_f32 v189, v162, v163
    v_rcp_f32 v39, v39
    v_cvt_pk_bf16_f32 v190, v164, v165
    v_cvt_pk_bf16_f32 v191, v166, v167
    v_mul_f32 v38, v39, v247
    v_mfma_f32_32x32x16_bf16 v[112:127], a[112:115], v[184:187], 0
    v_mul_f32 v168, v38, v168
    v_mul_f32 v169, v39, v169
    v_mul_f32 v170, v39, v170
    v_mul_f32 v171, v39, v171
    v_mul_f32 v172, v39, v172
    s_mul_i32 s47, s81, 229376
    s_add_u32 s47, s47, s53
    s_add_u32 s47, s47, 114688
    s_add_u32 m0, s57, 118784
    s_nop 0
    buffer_load_dwordx4 v249, s[24:27], s47 offen  lds
    v_mfma_f32_32x32x16_bf16 v[128:143], a[116:119], v[184:187], 0
    v_mul_f32 v173, v39, v173
    v_mov_b32 v32, v28
    v_mul_f32 v174, v39, v174
    v_mul_f32 v175, v39, v175
    v_cvt_pk_bf16_f32 v192, v168, v169
    v_mfma_f32_32x32x16_bf16 v[112:127], a[120:123], v[188:191], v[112:127]
    v_cvt_pk_bf16_f32 v193, v170, v171
    v_mov_b32 v33, v28
    v_cvt_pk_bf16_f32 v194, v172, v173
    v_cvt_pk_bf16_f32 v195, v174, v175
    v_mul_f32 v176, v39, v176
    s_mul_i32 s47, s82, 229376
    s_add_u32 s47, s47, s53
    s_add_u32 s47, s47, 0
    s_add_u32 m0, s57, 122880
    s_nop 0
    buffer_load_dwordx4 v249, s[24:27], s47 offen  lds
    v_mfma_f32_32x32x16_bf16 v[128:143], a[124:127], v[188:191], v[128:143]
    v_permlane32_swap_b32 v32, v33
    v_mul_f32 v177, v39, v177
    v_mul_f32 v178, v39, v178
    v_mul_f32 v179, v39, v179
    v_mul_f32 v180, v39, v180
    s_mul_i32 s47, s82, 229376
    s_add_u32 s47, s47, s53
    s_add_u32 s47, s47, 114688
    s_add_u32 m0, s57, 126976
    s_nop 0
    buffer_load_dwordx4 v249, s[24:27], s47 offen  lds
    s_waitcnt vmcnt(13)
    v_mfma_f32_32x32x16_bf16 v[152:167], v[224:227], a[232:235], 0
    v_add_f32 v35, 0x358637bd, v33
    v_mul_f32 v181, v39, v181
    v_mul_f32 v182, v39, v182
    v_mul_f32 v183, v39, v183
    v_cvt_pk_bf16_f32 v196, v176, v177
    s_waitcnt vmcnt(12)
    v_mfma_f32_32x32x16_bf16 v[152:167], v[228:231], a[236:239], v[152:167]
    v_rcp_f32 v35, v35
    v_cvt_pk_bf16_f32 v197, v178, v179
    v_cvt_pk_bf16_f32 v198, v180, v181
    v_cvt_pk_bf16_f32 v199, v182, v183
    v_mul_f32 v34, v35, v246
    v_mfma_f32_32x32x16_bf16 v[112:127], a[128:131], v[192:195], v[112:127]
    v_mul_f32 v16, v35, v16
    v_mul_f32 v17, v35, v17
    v_mul_f32 v18, v35, v18
    v_mul_f32 v19, v35, v19
    v_mul_f32 v20, v35, v20
    s_mul_i32 s47, s83, 229376
    s_add_u32 s47, s47, s53
    s_add_u32 s47, s47, 0
    s_add_u32 m0, s57, 131072
    s_nop 0
    buffer_load_dwordx4 v249, s[24:27], s47 offen  lds
    v_mfma_f32_32x32x16_bf16 v[128:143], a[132:135], v[192:195], v[128:143]
    v_mul_f32 v21, v35, v21
    v_mov_b32 v36, v152
    v_mul_f32 v22, v35, v22
    v_mul_f32 v23, v35, v23
    v_cvt_pk_bf16_f32 v184, v16, v17
    v_mfma_f32_32x32x16_bf16 v[112:127], a[136:139], v[196:199], v[112:127]
    v_cvt_pk_bf16_f32 v185, v18, v19
    v_mov_b32 v37, v152
    v_cvt_pk_bf16_f32 v186, v20, v21
    v_cvt_pk_bf16_f32 v187, v22, v23
    v_mul_f32 v24, v35, v24
    s_mul_i32 s47, s83, 229376
    s_add_u32 s47, s47, s53
    s_add_u32 s47, s47, 114688
    s_add_u32 m0, s57, 135168
    s_nop 0
    buffer_load_dwordx4 v249, s[24:27], s47 offen  lds
    v_mfma_f32_32x32x16_bf16 v[128:143], a[140:143], v[196:199], v[128:143]
    v_permlane32_swap_b32 v36, v37
    v_mul_f32 v25, v35, v25
    v_mul_f32 v26, v35, v26
    v_mul_f32 v27, v35, v27
    v_mul_f32 v28, v34, v28
    s_mul_i32 s47, s84, 229376
    s_add_u32 s47, s47, s53
    s_add_u32 s47, s47, 0
    s_add_u32 m0, s57, 139264
    s_nop 0
    buffer_load_dwordx4 v249, s[24:27], s47 offen  lds
    s_waitcnt vmcnt(14)
    v_mfma_f32_32x32x16_bf16 v[168:183], v[200:203], a[176:179], 0
    v_add_f32 v39, 0x358637bd, v36
    v_mul_f32 v29, v35, v29
    v_mul_f32 v30, v35, v30
    v_mul_f32 v31, v35, v31
    v_cvt_pk_bf16_f32 v188, v24, v25
    s_waitcnt vmcnt(13)
    v_mfma_f32_32x32x16_bf16 v[168:183], v[204:207], a[180:183], v[168:183]
    v_rcp_f32 v39, v39
    v_cvt_pk_bf16_f32 v189, v26, v27
    v_cvt_pk_bf16_f32 v190, v28, v29
    v_cvt_pk_bf16_f32 v191, v30, v31
    v_mul_f32 v38, v39, v247
    v_mfma_f32_32x32x16_bf16 v[112:127], a[144:147], v[184:187], v[112:127]
    v_mul_f32 v152, v38, v152
    v_mul_f32 v153, v39, v153
    v_mul_f32 v154, v39, v154
    v_mul_f32 v155, v39, v155
    v_mul_f32 v156, v39, v156
    s_mul_i32 s47, s84, 229376
    s_add_u32 s47, s47, s53
    s_add_u32 s47, s47, 114688
    s_add_u32 m0, s57, 143360
    s_nop 0
    buffer_load_dwordx4 v249, s[24:27], s47 offen  lds
    v_mfma_f32_32x32x16_bf16 v[128:143], a[148:151], v[184:187], v[128:143]
    v_mul_f32 v157, v39, v157
    v_mov_b32 v32, v180
    v_mul_f32 v158, v39, v158
    v_mul_f32 v159, v39, v159
    v_cvt_pk_bf16_f32 v192, v152, v153
    v_mfma_f32_32x32x16_bf16 v[112:127], a[152:155], v[188:191], v[112:127]
    v_cvt_pk_bf16_f32 v193, v154, v155
    v_mov_b32 v33, v180
    v_cvt_pk_bf16_f32 v194, v156, v157
    v_cvt_pk_bf16_f32 v195, v158, v159
    v_mul_f32 v160, v39, v160
    s_mul_i32 s47, s85, 229376
    s_add_u32 s47, s47, s53
    s_add_u32 s47, s47, 0
    s_add_u32 m0, s57, 147456
    s_nop 0
    buffer_load_dwordx4 v249, s[24:27], s47 offen  lds
    v_mfma_f32_32x32x16_bf16 v[128:143], a[156:159], v[188:191], v[128:143]
    v_permlane32_swap_b32 v32, v33
    v_mul_f32 v161, v39, v161
    v_mul_f32 v162, v39, v162
    v_mul_f32 v163, v39, v163
    v_mul_f32 v164, v39, v164
    s_mul_i32 s47, s85, 229376
    s_add_u32 s47, s47, s53
    s_add_u32 s47, s47, 114688
    s_add_u32 m0, s57, 151552
    s_nop 0
    buffer_load_dwordx4 v249, s[24:27], s47 offen  lds
    s_waitcnt vmcnt(15)
    v_mfma_f32_32x32x16_bf16 v[16:31], v[208:211], a[184:187], 0
    v_add_f32 v35, 0x358637bd, v33
    v_mul_f32 v165, v39, v165
    v_mul_f32 v166, v39, v166
    v_mul_f32 v167, v39, v167
    v_cvt_pk_bf16_f32 v196, v160, v161
    s_waitcnt vmcnt(14)
    v_mfma_f32_32x32x16_bf16 v[16:31], v[212:215], a[188:191], v[16:31]
    v_rcp_f32 v35, v35
    v_cvt_pk_bf16_f32 v197, v162, v163
    v_cvt_pk_bf16_f32 v198, v164, v165
    v_cvt_pk_bf16_f32 v199, v166, v167
    v_mul_f32 v34, v35, v246
    v_mfma_f32_32x32x16_bf16 v[112:127], a[160:163], v[192:195], v[112:127]
    v_mul_f32 v168, v35, v168
    v_mul_f32 v169, v35, v169
    v_mul_f32 v170, v35, v170
    v_mul_f32 v171, v35, v171
    v_mul_f32 v172, v35, v172
    s_mul_i32 s47, s86, 229376
    s_add_u32 s47, s47, s53
    s_add_u32 s47, s47, 0
    s_add_u32 m0, s57, 155648
    s_nop 0
    buffer_load_dwordx4 v249, s[24:27], s47 offen  lds
    v_mfma_f32_32x32x16_bf16 v[128:143], a[164:167], v[192:195], v[128:143]
    v_mul_f32 v173, v35, v173
    v_mov_b32 v36, v16
    v_mul_f32 v174, v35, v174
    v_mul_f32 v175, v35, v175
    v_cvt_pk_bf16_f32 v184, v168, v169
    v_mfma_f32_32x32x16_bf16 v[112:127], a[168:171], v[196:199], v[112:127]
    v_cvt_pk_bf16_f32 v185, v170, v171
    v_mov_b32 v37, v16
    v_cvt_pk_bf16_f32 v186, v172, v173
    v_cvt_pk_bf16_f32 v187, v174, v175
    v_mul_f32 v176, v35, v176
    v_mfma_f32_32x32x16_bf16 v[128:143], a[172:175], v[196:199], v[128:143]
    v_permlane32_swap_b32 v36, v37
    v_mul_f32 v177, v35, v177
    v_mul_f32 v178, v35, v178
    v_mul_f32 v179, v35, v179
    v_mul_f32 v180, v34, v180
    s_waitcnt vmcnt(14)
    v_mfma_f32_32x32x16_bf16 v[152:167], v[216:219], a[192:195], 0
    v_add_f32 v39, 0x358637bd, v36
    v_mul_f32 v181, v35, v181
    v_mul_f32 v182, v35, v182
    v_mul_f32 v183, v35, v183
    v_cvt_pk_bf16_f32 v188, v176, v177
    s_waitcnt vmcnt(13)
    v_mfma_f32_32x32x16_bf16 v[152:167], v[220:223], a[196:199], v[152:167]
    v_rcp_f32 v39, v39
    v_cvt_pk_bf16_f32 v189, v178, v179
    v_cvt_pk_bf16_f32 v190, v180, v181
    v_cvt_pk_bf16_f32 v191, v182, v183
    v_mul_f32 v38, v39, v247
    v_mfma_f32_32x32x16_bf16 v[80:95], a[112:115], v[184:187], 0
    v_mul_f32 v16, v38, v16
    v_mul_f32 v17, v39, v17
    v_mul_f32 v18, v39, v18
    v_mul_f32 v19, v39, v19
    v_mul_f32 v20, v39, v20
    v_mfma_f32_32x32x16_bf16 v[96:111], a[116:119], v[184:187], 0
    v_mul_f32 v21, v39, v21
    v_mov_b32 v32, v164
    v_mul_f32 v22, v39, v22
    v_mul_f32 v23, v39, v23
    v_cvt_pk_bf16_f32 v192, v16, v17
    v_mfma_f32_32x32x16_bf16 v[80:95], a[120:123], v[188:191], v[80:95]
    v_cvt_pk_bf16_f32 v193, v18, v19
    v_mov_b32 v33, v164
    v_cvt_pk_bf16_f32 v194, v20, v21
    v_cvt_pk_bf16_f32 v195, v22, v23
    v_mul_f32 v24, v39, v24
    ds_write_b128 v65, v[112:115] offset:0
    v_mfma_f32_32x32x16_bf16 v[96:111], a[124:127], v[188:191], v[96:111]
    v_permlane32_swap_b32 v32, v33
    v_mul_f32 v25, v39, v25
    v_mul_f32 v26, v39, v26
    v_mul_f32 v27, v39, v27
    v_mul_f32 v28, v39, v28
    ds_write_b128 v65, v[116:119] offset:1024
    s_waitcnt vmcnt(12)
    v_mfma_f32_32x32x16_bf16 v[168:183], v[224:227], a[200:203], 0
    v_add_f32 v35, 0x358637bd, v33
    v_mul_f32 v29, v39, v29
    v_mul_f32 v30, v39, v30
    v_mul_f32 v31, v39, v31
    v_cvt_pk_bf16_f32 v196, v24, v25
    ds_write_b128 v65, v[120:123] offset:2048
    s_waitcnt vmcnt(11)
    v_mfma_f32_32x32x16_bf16 v[168:183], v[228:231], a[204:207], v[168:183]
    v_rcp_f32 v35, v35
    v_cvt_pk_bf16_f32 v197, v26, v27
    v_cvt_pk_bf16_f32 v198, v28, v29
    v_cvt_pk_bf16_f32 v199, v30, v31
    v_mul_f32 v34, v35, v246
    ds_write_b128 v65, v[124:127] offset:3072
    v_mfma_f32_32x32x16_bf16 v[80:95], a[128:131], v[192:195], v[80:95]
    v_mul_f32 v152, v35, v152
    v_mul_f32 v153, v35, v153
    v_mul_f32 v154, v35, v154
    v_mul_f32 v155, v35, v155
    v_mul_f32 v156, v35, v156
    v_mul_f32 v157, v35, v157
    v_mov_b32 v36, v168
    ds_write_b128 v66, v[128:131] offset:0
    s_mul_i32 s47, s86, 229376
    s_add_u32 s47, s47, s53
    s_add_u32 s47, s47, 114688
    s_add_u32 m0, s57, 159744
    s_nop 0
    buffer_load_dwordx4 v249, s[24:27], s47 offen  lds
    v_mfma_f32_32x32x16_bf16 v[96:111], a[132:135], v[192:195], v[96:111]
    v_mul_f32 v158, v35, v158
    v_mul_f32 v159, v35, v159
    v_cvt_pk_bf16_f32 v184, v152, v153
    v_cvt_pk_bf16_f32 v185, v154, v155
    v_mov_b32 v37, v168
    v_cvt_pk_bf16_f32 v186, v156, v157
    v_cvt_pk_bf16_f32 v187, v158, v159
    v_mul_f32 v160, v35, v160
    ds_write_b128 v66, v[132:135] offset:1024
    v_mfma_f32_32x32x16_bf16 v[80:95], a[136:139], v[196:199], v[80:95]
    v_permlane32_swap_b32 v36, v37
    v_mul_f32 v161, v35, v161
    v_mul_f32 v162, v35, v162
    v_mul_f32 v163, v35, v163
    v_mul_f32 v164, v34, v164
    v_add_f32 v39, 0x358637bd, v36
    v_mul_f32 v165, v35, v165
    ds_write_b128 v66, v[136:139] offset:2048
    s_mul_i32 s47, s80, 229376
    s_add_u32 s47, s47, s53
    s_add_u32 s47, s47, 0
    s_add_u32 m0, s57, 106496
    s_nop 0
    buffer_load_dwordx4 v249, s[24:27], s47 offen  lds
    v_mfma_f32_32x32x16_bf16 v[96:111], a[140:143], v[196:199], v[96:111]
    v_mul_f32 v166, v35, v166
    v_mul_f32 v167, v35, v167
    v_cvt_pk_bf16_f32 v188, v160, v161
    v_rcp_f32 v39, v39
    v_cvt_pk_bf16_f32 v189, v162, v163
    v_cvt_pk_bf16_f32 v190, v164, v165
    v_cvt_pk_bf16_f32 v191, v166, v167
    v_mul_f32 v38, v39, v247
    ds_write_b128 v66, v[140:143] offset:3072
    s_mul_i32 s47, s80, 229376
    s_add_u32 s47, s47, s53
    s_add_u32 s47, s47, 114688
    s_add_u32 m0, s57, 110592
    s_nop 0
    buffer_load_dwordx4 v249, s[24:27], s47 offen  lds
    v_mfma_f32_32x32x16_bf16 v[80:95], a[144:147], v[184:187], v[80:95]
    v_mul_f32 v168, v38, v168
    v_mul_f32 v169, v39, v169
    v_mul_f32 v170, v39, v170
    v_mul_f32 v171, v39, v171
    v_mul_f32 v172, v39, v172
    v_mul_f32 v173, v39, v173
    s_mul_i32 s47, s80, 229376
    s_add_u32 s47, s47, s53
    s_add_u32 s47, s47, 0
    s_add_u32 m0, s57, 49152
    s_nop 0
    buffer_load_dwordx4 v248, s[20:23], s47 offen  lds
    v_mfma_f32_32x32x16_bf16 v[96:111], a[148:151], v[184:187], v[96:111]
    v_mul_f32 v174, v39, v174
    v_mul_f32 v175, v39, v175
    v_cvt_pk_bf16_f32 v192, v168, v169
    v_cvt_pk_bf16_f32 v193, v170, v171
    v_cvt_pk_bf16_f32 v194, v172, v173
    v_cvt_pk_bf16_f32 v195, v174, v175
    v_mfma_f32_32x32x16_bf16 v[80:95], a[152:155], v[188:191], v[80:95]
    v_mul_f32 v176, v39, v176
    v_mul_f32 v177, v39, v177
    v_mul_f32 v178, v39, v178
    v_mul_f32 v179, v39, v179
    v_mul_f32 v180, v39, v180
    v_mul_f32 v181, v39, v181
    s_mul_i32 s47, s80, 229376
    s_add_u32 s47, s47, s53
    s_add_u32 s47, s47, 114688
    s_add_u32 m0, s57, 53248
    s_nop 0
    buffer_load_dwordx4 v248, s[20:23], s47 offen  lds
    v_mfma_f32_32x32x16_bf16 v[96:111], a[156:159], v[188:191], v[96:111]
    v_mul_f32 v182, v39, v182
    v_mul_f32 v183, v39, v183
    v_cvt_pk_bf16_f32 v196, v176, v177
    v_cvt_pk_bf16_f32 v197, v178, v179
    v_cvt_pk_bf16_f32 v198, v180, v181
    v_cvt_pk_bf16_f32 v199, v182, v183
    s_mul_i32 s47, s81, 229376
    s_add_u32 s47, s47, s53
    s_add_u32 s47, s47, 0
    s_add_u32 m0, s57, 57344
    s_nop 0
    buffer_load_dwordx4 v248, s[20:23], s47 offen  lds
    v_mfma_f32_32x32x16_bf16 v[96:111], a[164:167], v[192:195], v[96:111]
    v_mfma_f32_32x32x16_bf16 v[96:111], a[172:175], v[196:199], v[96:111]
    v_mfma_f32_32x32x16_bf16 v[80:95], a[160:163], v[192:195], v[80:95]
    s_mul_i32 s47, s81, 229376
    s_add_u32 s47, s47, s53
    s_add_u32 s47, s47, 114688
    s_add_u32 m0, s57, 61440
    s_nop 0
    buffer_load_dwordx4 v248, s[20:23], s47 offen  lds
    s_mul_i32 s47, s82, 229376
    s_add_u32 s47, s47, s53
    s_add_u32 s47, s47, 0
    s_add_u32 m0, s57, 65536
    s_nop 0
    buffer_load_dwordx4 v248, s[20:23], s47 offen  lds
    s_mul_i32 s47, s82, 229376
    s_add_u32 s47, s47, s53
    s_add_u32 s47, s47, 114688
    s_add_u32 m0, s57, 69632
    s_nop 0
    buffer_load_dwordx4 v248, s[20:23], s47 offen  lds
    ds_write_b128 v64, v[96:99] offset:0
    ds_write_b128 v64, v[100:103] offset:1024
    ds_write_b128 v64, v[104:107] offset:2048
    ds_write_b128 v64, v[108:111] offset:3072
    v_mfma_f32_32x32x16_bf16 v[80:95], a[168:171], v[196:199], v[80:95]
    s_waitcnt lgkmcnt(0)
    s_barrier
    ds_read_b128 v[152:155], v67 offset:0
    ds_read_b128 v[156:159], v67 offset:1024
    ds_read_b128 v[160:163], v67 offset:2048
    ds_read_b128 v[164:167], v67 offset:3072
    ds_read_b128 v[168:171], v67 offset:4096
    ds_read_b128 v[172:175], v67 offset:5120
    ds_read_b128 v[176:179], v67 offset:6144
    ds_read_b128 v[180:183], v67 offset:7168
    ds_read_b128 v[184:187], v67 offset:8192
    ds_read_b128 v[188:191], v67 offset:9216
    ds_read_b128 v[192:195], v67 offset:10240
    ds_read_b128 v[196:199], v67 offset:11264
    v_dot2_f32_bf16 v80, v232, s91, v80
    v_dot2_f32_bf16 v81, v232, s92, v81
    v_dot2_f32_bf16 v82, v233, s91, v82
    v_dot2_f32_bf16 v83, v233, s92, v83
    v_dot2_f32_bf16 v84, v234, s91, v84
    v_dot2_f32_bf16 v85, v234, s92, v85
    v_dot2_f32_bf16 v86, v235, s91, v86
    v_dot2_f32_bf16 v87, v235, s92, v87
    v_dot2_f32_bf16 v88, v236, s91, v88
    v_dot2_f32_bf16 v89, v236, s92, v89
    v_dot2_f32_bf16 v90, v237, s91, v90
    v_dot2_f32_bf16 v91, v237, s92, v91
    v_dot2_f32_bf16 v92, v238, s91, v92
    v_dot2_f32_bf16 v93, v238, s92, v93
    v_dot2_f32_bf16 v94, v239, s91, v94
    v_dot2_f32_bf16 v95, v239, s92, v95
    s_waitcnt lgkmcnt(11)
    v_pk_add_f32 v[80:81], v[80:81], v[152:153]
    v_pk_add_f32 v[82:83], v[82:83], v[154:155]
    s_waitcnt lgkmcnt(10)
    v_pk_add_f32 v[84:85], v[84:85], v[156:157]
    v_pk_add_f32 v[86:87], v[86:87], v[158:159]
    s_waitcnt lgkmcnt(9)
    v_pk_add_f32 v[88:89], v[88:89], v[160:161]
    v_pk_add_f32 v[90:91], v[90:91], v[162:163]
    s_waitcnt lgkmcnt(8)
    v_pk_add_f32 v[92:93], v[92:93], v[164:165]
    v_pk_add_f32 v[94:95], v[94:95], v[166:167]
    s_waitcnt lgkmcnt(7)
    v_pk_add_f32 v[80:81], v[80:81], v[168:169]
    v_pk_add_f32 v[82:83], v[82:83], v[170:171]
    s_waitcnt lgkmcnt(6)
    v_pk_add_f32 v[84:85], v[84:85], v[172:173]
    v_pk_add_f32 v[86:87], v[86:87], v[174:175]
    s_waitcnt lgkmcnt(5)
    v_pk_add_f32 v[88:89], v[88:89], v[176:177]
    v_pk_add_f32 v[90:91], v[90:91], v[178:179]
    s_waitcnt lgkmcnt(4)
    v_pk_add_f32 v[92:93], v[92:93], v[180:181]
    v_pk_add_f32 v[94:95], v[94:95], v[182:183]
    s_waitcnt lgkmcnt(3)
    v_pk_add_f32 v[80:81], v[80:81], v[184:185]
    v_pk_add_f32 v[82:83], v[82:83], v[186:187]
    s_waitcnt lgkmcnt(2)
    v_pk_add_f32 v[84:85], v[84:85], v[188:189]
    v_pk_add_f32 v[86:87], v[86:87], v[190:191]
    s_waitcnt lgkmcnt(1)
    v_pk_add_f32 v[88:89], v[88:89], v[192:193]
    v_pk_add_f32 v[90:91], v[90:91], v[194:195]
    s_waitcnt lgkmcnt(0)
    v_pk_add_f32 v[92:93], v[92:93], v[196:197]
    v_pk_add_f32 v[94:95], v[94:95], v[198:199]
    v_cvt_pk_bf16_f32 v144, v80, v81
    v_cvt_pk_bf16_f32 v145, v82, v83
    v_cvt_pk_bf16_f32 v146, v84, v85
    v_cvt_pk_bf16_f32 v147, v86, v87
    v_cvt_pk_bf16_f32 v148, v88, v89
    v_cvt_pk_bf16_f32 v149, v90, v91
    v_cvt_pk_bf16_f32 v150, v92, v93
    v_cvt_pk_bf16_f32 v151, v94, v95
    v_min_u32 v144, -2, v144
    v_min_u32 v145, -2, v145
    v_min_u32 v146, -2, v146
    v_min_u32 v147, -2, v147
    v_min_u32 v148, -2, v148
    v_min_u32 v149, -2, v149
    v_min_u32 v150, -2, v150
    v_min_u32 v151, -2, v151
    buffer_store_dwordx4 v[144:147], v2, s[36:39], s100 offen sc1
    buffer_store_dwordx4 v[148:151], v2, s[36:39], s100 offen offset:1024 sc1
    s_lshl_b32 s73, s42, 7
    s_add_u32 s73, s73, 8945664
    v_mov_b32 v1, 28
    s_mov_b64 exec, 1
    buffer_load_dword v1, v2, s[36:39], s73 offen sc1
    s_mov_b64 exec, -1
    v_pk_mul_f32 v[6:7], v[80:81], v[80:81]
    v_pk_add_f32 v[4:5], v[80:81], v[82:83]
    v_pk_fma_f32 v[6:7], v[82:83], v[82:83], v[6:7]
    v_pk_fma_f32 v[6:7], v[84:85], v[84:85], v[6:7]
    v_pk_add_f32 v[4:5], v[4:5], v[84:85]
    v_pk_fma_f32 v[6:7], v[86:87], v[86:87], v[6:7]
    v_pk_add_f32 v[4:5], v[4:5], v[86:87]
    v_pk_fma_f32 v[6:7], v[88:89], v[88:89], v[6:7]
    v_pk_add_f32 v[4:5], v[4:5], v[88:89]
    v_pk_fma_f32 v[6:7], v[90:91], v[90:91], v[6:7]
    v_pk_add_f32 v[4:5], v[4:5], v[90:91]
    v_pk_fma_f32 v[6:7], v[92:93], v[92:93], v[6:7]
    v_pk_add_f32 v[4:5], v[4:5], v[92:93]
    v_pk_fma_f32 v[6:7], v[94:95], v[94:95], v[6:7]
    v_pk_add_f32 v[4:5], v[4:5], v[94:95]
    v_add_f32 v4, v4, v5
    v_add_f32 v5, v6, v7
    v_mov_b32 v6, v4
    v_mov_b32 v7, v5
    s_nop 0
    v_permlane32_swap_b32 v4, v6
    v_permlane32_swap_b32 v5, v7
    v_pk_add_f32 v[4:5], v[4:5], v[6:7]
    s_xor_b32 s87, s42, 1
    s_mul_i32 s87, s87, 12288
    s_mul_i32 s97, s42, 12288
    v_lshlrev_b32 v3, 3, v0
    v_add_u32 v6, s87, v3
    v_add_u32 v3, s97, v3
    s_barrier
    ds_write_b64 v6, v[4:5] offset:10240
    s_waitcnt lgkmcnt(0)
    s_barrier
    ds_read_b64 v[6:7], v3 offset:10240
    s_waitcnt lgkmcnt(0)
    v_pk_add_f32 v[4:5], v[4:5], v[6:7]
    v_min_u32 v4, -2, v4
    v_min_u32 v5, -2, v5
    s_mov_b32 exec_hi, 0
    buffer_store_dwordx2 v[4:5], v2, s[36:39], s101 offen sc1
    s_mov_b64 exec, -1
    s_mul_i32 s47, s83, 229376
    s_add_u32 s47, s47, s53
    s_add_u32 s47, s47, 0
    s_add_u32 m0, s57, 73728
    s_nop 0
    buffer_load_dwordx4 v248, s[20:23], s47 offen  lds
    s_mul_i32 s47, s83, 229376
    s_add_u32 s47, s47, s53
    s_add_u32 s47, s47, 114688
    s_add_u32 m0, s57, 77824
    s_nop 0
    buffer_load_dwordx4 v248, s[20:23], s47 offen  lds
    s_mul_i32 s47, s84, 229376
    s_add_u32 s47, s47, s53
    s_add_u32 s47, s47, 0
    s_add_u32 m0, s57, 81920
    s_nop 0
    buffer_load_dwordx4 v248, s[20:23], s47 offen  lds
    s_mul_i32 s47, s84, 229376
    s_add_u32 s47, s47, s53
    s_add_u32 s47, s47, 114688
    s_add_u32 m0, s57, 86016
    s_nop 0
    buffer_load_dwordx4 v248, s[20:23], s47 offen  lds
    s_mul_i32 s47, s85, 229376
    s_add_u32 s47, s47, s53
    s_add_u32 s47, s47, 0
    s_add_u32 m0, s57, 90112
    s_nop 0
    buffer_load_dwordx4 v248, s[20:23], s47 offen  lds
    s_mul_i32 s47, s85, 229376
    s_add_u32 s47, s47, s53
    s_add_u32 s47, s47, 114688
    s_add_u32 m0, s57, 94208
    s_nop 0
    buffer_load_dwordx4 v248, s[20:23], s47 offen  lds
    s_mul_i32 s47, s86, 229376
    s_add_u32 s47, s47, s53
    s_add_u32 s47, s47, 0
    s_add_u32 m0, s57, 98304
    s_nop 0
    buffer_load_dwordx4 v248, s[20:23], s47 offen  lds
    s_mul_i32 s47, s86, 229376
    s_add_u32 s47, s47, s53
    s_add_u32 s47, s47, 114688
    s_add_u32 m0, s57, 102400
    s_nop 0
    buffer_load_dwordx4 v248, s[20:23], s47 offen  lds
    s_and_b32 s87, s43, 3
    s_lshl_b32 s87, s87, 1
    s_add_u32 s87, s87, s44
    s_cmp_ge_u32 s87, 7
    s_cselect_b32 s88, 7, 0
    s_sub_u32 s87, s87, s88
    s_add_u32 s50, s87, 0
    s_cmp_ge_u32 s50, 7
    s_cselect_b32 s88, 7, 0
    s_sub_u32 s50, s50, s88
    s_add_u32 s51, s87, 1
    s_cmp_ge_u32 s51, 7
    s_cselect_b32 s88, 7, 0
    s_sub_u32 s51, s51, s88
    s_add_u32 s52, s87, 2
    s_cmp_ge_u32 s52, 7
    s_cselect_b32 s88, 7, 0
    s_sub_u32 s52, s52, s88
    s_add_u32 s53, s87, 3
    s_cmp_ge_u32 s53, 7
    s_cselect_b32 s88, 7, 0
    s_sub_u32 s53, s53, s88
    s_add_u32 s54, s87, 4
    s_cmp_ge_u32 s54, 7
    s_cselect_b32 s88, 7, 0
    s_sub_u32 s54, s54, s88
    s_add_u32 s55, s87, 5
    s_cmp_ge_u32 s55, 7
    s_cselect_b32 s88, 7, 0
    s_sub_u32 s55, s55, s88
    s_add_u32 s56, s87, 6
    s_cmp_ge_u32 s56, 7
    s_cselect_b32 s88, 7, 0
    s_sub_u32 s56, s56, s88
    s_mul_i32 s96, s44, 112
    s_mul_i32 s88, s42, 28
    s_add_u32 s96, s96, s88
    s_lshl_b32 s96, s96, 11
    s_add_u32 s96, s96, 17825792
    s_lshl_b32 s88, s76, 10
    v_add_u32 v38, s88, v2
    s_xor_b32 s88, s88, 1024
    v_add_u32 v39, s88, v2
    v_bfe_u32 v40, v0, 2, 2
    v_lshrrev_b32 v41, 5, v0
    v_lshl_add_u32 v40, v41, 2, v40
    v_lshlrev_b32 v40, 7, v40
    v_bfe_u32 v41, v0, 4, 1
    v_mul_u32_u24 v42, 57344, v41
    v_add_u32 v40, v40, v42
    v_and_b32 v42, 3, v0
    v_lshl_add_u32 v40, v42, 3, v40
    v_add_u32 v40, 49152, v40
    v_lshlrev_b32 v41, 1, v41
    v_bfe_u32 v42, v0, 3, 1
    v_add_u32 v41, v41, v42
    v_xor_b32 v42, 0, v41
    v_lshl_add_u32 v10, v42, 5, v40
    v_xor_b32 v42, 1, v41
    v_lshl_add_u32 v11, v42, 5, v40
    v_xor_b32 v42, 2, v41
    v_lshl_add_u32 v12, v42, 5, v40
    v_xor_b32 v42, 3, v41
    v_lshl_add_u32 v13, v42, 5, v40
    v_mov_b32 v34, 0
    v_mov_b32 v35, 0
    v_mov_b32 v18, 0
    v_mov_b32 v19, 0
    v_mov_b32 v22, 0
    v_mov_b32 v23, 0
    s_mul_i32 s89, s78, 57344
    s_add_u32 s89, s89, 2097152
    s_lshl_b32 s49, s78, 12
    s_add_u32 s49, s49, 8454144
    s_lshl_b32 s46, s58, 11
    s_add_u32 s46, s46, 8454144
    s_mov_b32 s93, 0
    s_waitcnt vmcnt(0)
    s_barrier
    v_cmp_gt_u32 vcc, 28, v1
    s_nop 3
    s_cbranch_vccnz Lwf14_slow
Lwf14:
Lp315:
    ds_read_b64_tr_b16 v[40:41], v10 offset:0
    ds_read_b64_tr_b16 v[42:43], v10 offset:1024
    ds_read_b64_tr_b16 v[44:45], v11 offset:0
    ds_read_b64_tr_b16 v[46:47], v11 offset:1024
    ds_read_b64_tr_b16 v[48:49], v10 offset:2048
    ds_read_b64_tr_b16 v[50:51], v10 offset:3072
    s_mov_b32 s59, 0
Lp3b17:
    buffer_load_dwordx4 v[56:59], v2, s[36:39], s49 offen offset:0 sc1
    buffer_load_dwordx4 v[60:63], v2, s[36:39], s49 offen offset:1024 sc1
    buffer_load_dwordx4 v[64:67], v2, s[36:39], s49 offen offset:2048 sc1
    buffer_load_dwordx4 v[68:71], v2, s[36:39], s49 offen offset:3072 sc1
    buffer_load_dwordx4 v[72:75], v2, s[36:39], s46 offen offset:0 sc1
    buffer_load_dwordx4 v[76:79], v2, s[36:39], s46 offen offset:1024 sc1
    buffer_load_dwordx4 v[24:27], v2, s[36:39], s3 offen offset:0 sc1
    buffer_load_dwordx4 v[28:31], v2, s[36:39], s3 offen offset:1024 sc1
    s_lshl_b32 s87, s80, 12
    s_add_u32 s87, s87, s89
    s_add_u32 s88, s87, 28672
    buffer_load_dwordx4 a[0:3], v2, s[36:39], s87 offen offset:0 sc1
    buffer_load_dwordx4 a[112:115], v2, s[36:39], s88 offen offset:0 sc1
    buffer_load_dwordx4 a[4:7], v2, s[36:39], s87 offen offset:1024 sc1
    buffer_load_dwordx4 a[116:119], v2, s[36:39], s88 offen offset:1024 sc1
    v_cmp_gt_u32 vcc, 32, v0
    s_waitcnt vmcnt(10)
    s_nop 0
    v_cndmask_b32 v62, 0, v62, vcc
    v_cndmask_b32 v63, 0, v63, vcc
    s_waitcnt vmcnt(8)
    v_cndmask_b32 v70, 0, v70, vcc
    v_cndmask_b32 v71, 0, v71, vcc
    s_waitcnt vmcnt(6)
    v_cndmask_b32 v78, 0, v78, vcc
    v_cndmask_b32 v79, 0, v79, vcc
    v_max3_u32 v4, v56, v57, v58
    v_max3_u32 v5, v59, v60, v61
    v_max3_u32 v4, v4, v62, v63
    v_max3_u32 v5, v5, v64, v65
    v_max3_u32 v4, v4, v66, v67
    v_max3_u32 v5, v5, v68, v69
    v_max3_u32 v4, v4, v70, v71
    v_max3_u32 v5, v5, v72, v73
    v_max3_u32 v4, v4, v74, v75
    v_max3_u32 v5, v5, v76, v77
    v_max3_u32 v4, v4, v78, v79
    v_max_u32 v4, v4, v5
    v_cmp_eq_u32 vcc, -1, v4
    s_nop 3
    s_cbranch_vccnz Lstslow
Lstok:
    buffer_load_dwordx4 a[8:11], v2, s[36:39], s87 offen offset:2048 sc1
    buffer_load_dwordx4 a[120:123], v2, s[36:39], s88 offen offset:2048 sc1
    buffer_load_dwordx4 a[12:15], v2, s[36:39], s87 offen offset:3072 sc1
    buffer_load_dwordx4 a[124:127], v2, s[36:39], s88 offen offset:3072 sc1
    s_lshl_b32 s87, s81, 12
    s_add_u32 s87, s87, s89
    s_add_u32 s88, s87, 28672
    buffer_load_dwordx4 a[16:19], v2, s[36:39], s87 offen offset:0 sc1
    buffer_load_dwordx4 a[128:131], v2, s[36:39], s88 offen offset:0 sc1
    s_waitcnt vmcnt(9) lgkmcnt(4)
    v_mfma_f32_32x32x16_bf16 v[80:95], v[40:43], a[0:3], 0
    ds_read_b64_tr_b16 v[52:53], v11 offset:2048
    buffer_load_dwordx4 a[20:23], v2, s[36:39], s87 offen offset:1024 sc1
    s_waitcnt vmcnt(9)
    v_mfma_f32_32x32x16_bf16 v[96:111], v[40:43], a[112:115], 0
    ds_read_b64_tr_b16 v[54:55], v11 offset:3072
    s_waitcnt lgkmcnt(4)
    v_mfma_f32_32x32x16_bf16 v[112:127], v[44:47], a[0:3], 0
    ds_read_b64_tr_b16 v[40:41], v10 offset:4096
    buffer_load_dwordx4 a[132:135], v2, s[36:39], s88 offen offset:1024 sc1
    v_mfma_f32_32x32x16_bf16 v[128:143], v[44:47], a[112:115], 0
    ds_read_b64_tr_b16 v[42:43], v10 offset:5120
    s_waitcnt vmcnt(9) lgkmcnt(4)
    v_mfma_f32_32x32x16_bf16 v[80:95], v[48:51], a[4:7], v[80:95]
    ds_read_b64_tr_b16 v[44:45], v11 offset:4096
    buffer_load_dwordx4 a[24:27], v2, s[36:39], s87 offen offset:2048 sc1
    s_waitcnt vmcnt(9)
    v_mfma_f32_32x32x16_bf16 v[96:111], v[48:51], a[116:119], v[96:111]
    ds_read_b64_tr_b16 v[46:47], v11 offset:5120
    s_waitcnt lgkmcnt(4)
    v_mfma_f32_32x32x16_bf16 v[112:127], v[52:55], a[4:7], v[112:127]
    ds_read_b64_tr_b16 v[48:49], v10 offset:6144
    buffer_load_dwordx4 a[136:139], v2, s[36:39], s88 offen offset:2048 sc1
    v_mfma_f32_32x32x16_bf16 v[128:143], v[52:55], a[116:119], v[128:143]
    ds_read_b64_tr_b16 v[50:51], v10 offset:7168
    s_waitcnt vmcnt(9) lgkmcnt(4)
    v_mfma_f32_32x32x16_bf16 v[80:95], v[40:43], a[8:11], v[80:95]
    ds_read_b64_tr_b16 v[52:53], v11 offset:6144
    buffer_load_dwordx4 a[28:31], v2, s[36:39], s87 offen offset:3072 sc1
    v_cmp_gt_u32 vcc, 32, v0
    v_add_f32 v56, v56, v58
    v_add_f32 v57, v57, v59
    v_add_f32 v56, v56, v60
    s_waitcnt vmcnt(9)
    v_mfma_f32_32x32x16_bf16 v[96:111], v[40:43], a[120:123], v[96:111]
    ds_read_b64_tr_b16 v[54:55], v11 offset:7168
    v_add_f32 v57, v57, v61
    v_add_f32 v56, v56, v62
    v_add_f32 v57, v57, v63
    v_mov_b32 v58, v56
    v_mov_b32 v59, v57
    s_waitcnt lgkmcnt(4)
    v_mfma_f32_32x32x16_bf16 v[112:127], v[44:47], a[8:11], v[112:127]
    ds_read_b64_tr_b16 v[40:41], v10 offset:8192
    buffer_load_dwordx4 a[140:143], v2, s[36:39], s88 offen offset:3072 sc1
    v_permlane32_swap_b32 v56, v58
    v_permlane32_swap_b32 v57, v59
    v_mfma_f32_32x32x16_bf16 v[128:143], v[44:47], a[120:123], v[128:143]
    ds_read_b64_tr_b16 v[42:43], v10 offset:9216
    v_add_f32 v56, v56, v58
    v_add_f32 v57, v57, v59
    v_mul_f32 v60, 0xbb124925, v56
    v_mul_f32 v58, v60, v60
    s_waitcnt vmcnt(9) lgkmcnt(4)
    v_mfma_f32_32x32x16_bf16 v[80:95], v[48:51], a[12:15], v[80:95]
    ds_read_b64_tr_b16 v[44:45], v11 offset:8192
    s_lshl_b32 s87, s82, 12
    s_add_u32 s87, s87, s89
    s_add_u32 s88, s87, 28672
    buffer_load_dwordx4 a[32:35], v2, s[36:39], s87 offen offset:0 sc1
    v_mul_f32 v57, s70, v57
    s_waitcnt vmcnt(9)
    v_mfma_f32_32x32x16_bf16 v[96:111], v[48:51], a[124:127], v[96:111]
    ds_read_b64_tr_b16 v[46:47], v11 offset:9216
    v_sub_f32 v57, v57, v58
    v_add_f32 v57, 0x3727c5ac, v57
    v_rsq_f32 v61, v57
    s_waitcnt lgkmcnt(4)
    v_mfma_f32_32x32x16_bf16 v[112:127], v[52:55], a[12:15], v[112:127]
    ds_read_b64_tr_b16 v[48:49], v10 offset:10240
    buffer_load_dwordx4 a[144:147], v2, s[36:39], s88 offen offset:0 sc1
    v_mul_f32 v36, 0xbfb8aa3b, v61
    v_cvt_pk_bf16_f32 v62, v60, v60
    v_and_b32 v63, s69, v62
    v_sub_f32 v63, v60, v63
    v_mfma_f32_32x32x16_bf16 v[128:143], v[52:55], a[124:127], v[128:143]
    ds_read_b64_tr_b16 v[50:51], v10 offset:11264
    v_cvt_pk_bf16_f32 v63, v63, 0
    v_cndmask_b32 v16, 0, v62, vcc
    v_cndmask_b32 v17, 0, v63, vcc
    v_add_f32 v64, v64, v66
    s_waitcnt vmcnt(9) lgkmcnt(4)
    v_mfma_f32_32x32x16_bf16 v[80:95], v[40:43], a[16:19], v[80:95]
    ds_read_b64_tr_b16 v[52:53], v11 offset:10240
    buffer_load_dwordx4 a[36:39], v2, s[36:39], s87 offen offset:1024 sc1
    v_add_f32 v65, v65, v67
    v_add_f32 v64, v64, v68
    v_add_f32 v65, v65, v69
    v_add_f32 v64, v64, v70
    s_waitcnt vmcnt(9)
    v_mfma_f32_32x32x16_bf16 v[96:111], v[40:43], a[128:131], v[96:111]
    ds_read_b64_tr_b16 v[54:55], v11 offset:11264
    v_add_f32 v65, v65, v71
    v_mov_b32 v66, v64
    v_mov_b32 v67, v65
    s_nop 0
    v_permlane32_swap_b32 v64, v66
    s_waitcnt lgkmcnt(4)
    v_mfma_f32_32x32x16_bf16 v[112:127], v[44:47], a[16:19], v[112:127]
    ds_read_b64_tr_b16 v[40:41], v10 offset:12288
    buffer_load_dwordx4 a[148:151], v2, s[36:39], s88 offen offset:1024 sc1
    v_permlane32_swap_b32 v65, v67
    v_add_f32 v64, v64, v66
    v_mfma_f32_32x32x16_bf16 v[128:143], v[44:47], a[128:131], v[128:143]
    ds_read_b64_tr_b16 v[42:43], v10 offset:13312
    v_add_f32 v65, v65, v67
    v_mul_f32 v68, 0xbb124925, v64
    v_mul_f32 v66, v68, v68
    v_mul_f32 v65, s70, v65
    v_sub_f32 v65, v65, v66
    s_waitcnt vmcnt(9) lgkmcnt(4)
    v_mfma_f32_32x32x16_bf16 v[80:95], v[48:51], a[20:23], v[80:95]
    ds_read_b64_tr_b16 v[44:45], v11 offset:12288
    buffer_load_dwordx4 a[40:43], v2, s[36:39], s87 offen offset:2048 sc1
    v_add_f32 v65, 0x3727c5ac, v65
    v_rsq_f32 v69, v65
    s_waitcnt vmcnt(9)
    v_mfma_f32_32x32x16_bf16 v[96:111], v[48:51], a[132:135], v[96:111]
    ds_read_b64_tr_b16 v[46:47], v11 offset:13312
    v_mul_f32 v37, 0xbfb8aa3b, v69
    v_cvt_pk_bf16_f32 v70, v68, v68
    v_and_b32 v71, s69, v70
    v_sub_f32 v71, v68, v71
    v_cvt_pk_bf16_f32 v71, v71, 0
    s_waitcnt lgkmcnt(4)
    v_mfma_f32_32x32x16_bf16 v[112:127], v[52:55], a[20:23], v[112:127]
    ds_read_b64_tr_b16 v[48:49], v10 offset:14336
    buffer_load_dwordx4 a[152:155], v2, s[36:39], s88 offen offset:2048 sc1
    v_cndmask_b32 v20, 0, v70, vcc
    v_cndmask_b32 v21, 0, v71, vcc
    v_add_f32 v72, v72, v74
    v_mfma_f32_32x32x16_bf16 v[128:143], v[52:55], a[132:135], v[128:143]
    ds_read_b64_tr_b16 v[50:51], v10 offset:15360
    v_add_f32 v73, v73, v75
    v_add_f32 v72, v72, v76
    v_add_f32 v73, v73, v77
    v_add_f32 v72, v72, v78
    v_add_f32 v73, v73, v79
    s_waitcnt vmcnt(9) lgkmcnt(4)
    v_mfma_f32_32x32x16_bf16 v[80:95], v[40:43], a[24:27], v[80:95]
    ds_read_b64_tr_b16 v[52:53], v11 offset:14336
    buffer_load_dwordx4 a[44:47], v2, s[36:39], s87 offen offset:3072 sc1
    v_mov_b32 v74, v72
    v_mov_b32 v75, v73
    s_nop 0
    v_permlane32_swap_b32 v72, v74
    s_waitcnt vmcnt(9)
    v_mfma_f32_32x32x16_bf16 v[96:111], v[40:43], a[136:139], v[96:111]
    ds_read_b64_tr_b16 v[54:55], v11 offset:15360
    v_permlane32_swap_b32 v73, v75
    v_add_f32 v72, v72, v74
    v_add_f32 v73, v73, v75
    s_waitcnt lgkmcnt(4)
    v_mfma_f32_32x32x16_bf16 v[112:127], v[44:47], a[24:27], v[112:127]
    ds_read_b64_tr_b16 v[40:41], v10 offset:16384
    buffer_load_dwordx4 a[156:159], v2, s[36:39], s88 offen offset:3072 sc1
    v_mul_f32 v76, 0xbb124925, v72
    v_mul_f32 v74, v76, v76
    v_mul_f32 v73, s70, v73
    v_mfma_f32_32x32x16_bf16 v[128:143], v[44:47], a[136:139], v[128:143]
    ds_read_b64_tr_b16 v[42:43], v10 offset:17408
    v_sub_f32 v73, v73, v74
    v_add_f32 v73, 0x3727c5ac, v73
    v_rsq_f32 v9, v73
    s_waitcnt vmcnt(9) lgkmcnt(4)
    v_mfma_f32_32x32x16_bf16 v[80:95], v[48:51], a[28:31], v[80:95]
    ds_read_b64_tr_b16 v[44:45], v11 offset:16384
    s_lshl_b32 s87, s83, 12
    s_add_u32 s87, s87, s89
    s_add_u32 s88, s87, 28672
    buffer_load_dwordx4 a[48:51], v2, s[36:39], s87 offen offset:0 sc1
    s_waitcnt vmcnt(9)
    v_mfma_f32_32x32x16_bf16 v[96:111], v[48:51], a[140:143], v[96:111]
    ds_read_b64_tr_b16 v[46:47], v11 offset:17408
    s_waitcnt lgkmcnt(4)
    v_mfma_f32_32x32x16_bf16 v[112:127], v[52:55], a[28:31], v[112:127]
    ds_read_b64_tr_b16 v[48:49], v10 offset:18432
    buffer_load_dwordx4 a[160:163], v2, s[36:39], s88 offen offset:0 sc1
    v_mfma_f32_32x32x16_bf16 v[128:143], v[52:55], a[140:143], v[128:143]
    ds_read_b64_tr_b16 v[50:51], v10 offset:19456
    s_waitcnt vmcnt(9) lgkmcnt(4)
    v_mfma_f32_32x32x16_bf16 v[80:95], v[40:43], a[32:35], v[80:95]
    ds_read_b64_tr_b16 v[52:53], v11 offset:18432
    buffer_load_dwordx4 a[52:55], v2, s[36:39], s87 offen offset:1024 sc1
    s_waitcnt vmcnt(9)
    v_mfma_f32_32x32x16_bf16 v[96:111], v[40:43], a[144:147], v[96:111]
    ds_read_b64_tr_b16 v[54:55], v11 offset:19456
    s_waitcnt lgkmcnt(4)
    v_mfma_f32_32x32x16_bf16 v[112:127], v[44:47], a[32:35], v[112:127]
    ds_read_b64_tr_b16 v[40:41], v10 offset:20480
    buffer_load_dwordx4 a[164:167], v2, s[36:39], s88 offen offset:1024 sc1
    v_mfma_f32_32x32x16_bf16 v[128:143], v[44:47], a[144:147], v[128:143]
    ds_read_b64_tr_b16 v[42:43], v10 offset:21504
    s_waitcnt vmcnt(9) lgkmcnt(4)
    v_mfma_f32_32x32x16_bf16 v[80:95], v[48:51], a[36:39], v[80:95]
    ds_read_b64_tr_b16 v[44:45], v11 offset:20480
    buffer_load_dwordx4 a[56:59], v2, s[36:39], s87 offen offset:2048 sc1
    s_waitcnt vmcnt(9)
    v_mfma_f32_32x32x16_bf16 v[96:111], v[48:51], a[148:151], v[96:111]
    ds_read_b64_tr_b16 v[46:47], v11 offset:21504
    s_waitcnt lgkmcnt(4)
    v_mfma_f32_32x32x16_bf16 v[112:127], v[52:55], a[36:39], v[112:127]
    ds_read_b64_tr_b16 v[48:49], v10 offset:22528
    buffer_load_dwordx4 a[168:171], v2, s[36:39], s88 offen offset:2048 sc1
    v_mfma_f32_32x32x16_bf16 v[128:143], v[52:55], a[148:151], v[128:143]
    ds_read_b64_tr_b16 v[50:51], v10 offset:23552
    s_waitcnt vmcnt(9) lgkmcnt(4)
    v_mfma_f32_32x32x16_bf16 v[80:95], v[40:43], a[40:43], v[80:95]
    ds_read_b64_tr_b16 v[52:53], v11 offset:22528
    buffer_load_dwordx4 a[60:63], v2, s[36:39], s87 offen offset:3072 sc1
    s_waitcnt vmcnt(9)
    v_mfma_f32_32x32x16_bf16 v[96:111], v[40:43], a[152:155], v[96:111]
    ds_read_b64_tr_b16 v[54:55], v11 offset:23552
    s_waitcnt lgkmcnt(4)
    v_mfma_f32_32x32x16_bf16 v[112:127], v[44:47], a[40:43], v[112:127]
    ds_read_b64_tr_b16 v[40:41], v10 offset:24576
    buffer_load_dwordx4 a[172:175], v2, s[36:39], s88 offen offset:3072 sc1
    v_mfma_f32_32x32x16_bf16 v[128:143], v[44:47], a[152:155], v[128:143]
    ds_read_b64_tr_b16 v[42:43], v10 offset:25600
    s_waitcnt vmcnt(9) lgkmcnt(4)
    v_mfma_f32_32x32x16_bf16 v[80:95], v[48:51], a[44:47], v[80:95]
    ds_read_b64_tr_b16 v[44:45], v11 offset:24576
    s_lshl_b32 s87, s84, 12
    s_add_u32 s87, s87, s89
    s_add_u32 s88, s87, 28672
    buffer_load_dwordx4 a[64:67], v2, s[36:39], s87 offen offset:0 sc1
    s_waitcnt vmcnt(9)
    v_mfma_f32_32x32x16_bf16 v[96:111], v[48:51], a[156:159], v[96:111]
    ds_read_b64_tr_b16 v[46:47], v11 offset:25600
    s_waitcnt lgkmcnt(4)
    v_mfma_f32_32x32x16_bf16 v[112:127], v[52:55], a[44:47], v[112:127]
    ds_read_b64_tr_b16 v[48:49], v10 offset:26624
    buffer_load_dwordx4 a[176:179], v2, s[36:39], s88 offen offset:0 sc1
    v_mfma_f32_32x32x16_bf16 v[128:143], v[52:55], a[156:159], v[128:143]
    ds_read_b64_tr_b16 v[50:51], v10 offset:27648
    s_waitcnt vmcnt(9) lgkmcnt(4)
    v_mfma_f32_32x32x16_bf16 v[80:95], v[40:43], a[48:51], v[80:95]
    ds_read_b64_tr_b16 v[52:53], v11 offset:26624
    buffer_load_dwordx4 a[68:71], v2, s[36:39], s87 offen offset:1024 sc1
    s_waitcnt vmcnt(9)
    v_mfma_f32_32x32x16_bf16 v[96:111], v[40:43], a[160:163], v[96:111]
    ds_read_b64_tr_b16 v[54:55], v11 offset:27648
    s_waitcnt lgkmcnt(4)
    v_mfma_f32_32x32x16_bf16 v[112:127], v[44:47], a[48:51], v[112:127]
    ds_read_b64_tr_b16 v[40:41], v10 offset:28672
    buffer_load_dwordx4 a[180:183], v2, s[36:39], s88 offen offset:1024 sc1
    v_mfma_f32_32x32x16_bf16 v[128:143], v[44:47], a[160:163], v[128:143]
    ds_read_b64_tr_b16 v[42:43], v10 offset:29696
    s_waitcnt vmcnt(9) lgkmcnt(4)
    v_mfma_f32_32x32x16_bf16 v[80:95], v[48:51], a[52:55], v[80:95]
    ds_read_b64_tr_b16 v[44:45], v11 offset:28672
    buffer_load_dwordx4 a[72:75], v2, s[36:39], s87 offen offset:2048 sc1
    s_waitcnt vmcnt(9)
    v_mfma_f32_32x32x16_bf16 v[96:111], v[48:51], a[164:167], v[96:111]
    ds_read_b64_tr_b16 v[46:47], v11 offset:29696
    s_waitcnt lgkmcnt(4)
    v_mfma_f32_32x32x16_bf16 v[112:127], v[52:55], a[52:55], v[112:127]
    ds_read_b64_tr_b16 v[48:49], v10 offset:30720
    buffer_load_dwordx4 a[184:187], v2, s[36:39], s88 offen offset:2048 sc1
    v_mfma_f32_32x32x16_bf16 v[128:143], v[52:55], a[164:167], v[128:143]
    ds_read_b64_tr_b16 v[50:51], v10 offset:31744
    s_waitcnt vmcnt(9) lgkmcnt(4)
    v_mfma_f32_32x32x16_bf16 v[80:95], v[40:43], a[56:59], v[80:95]
    ds_read_b64_tr_b16 v[52:53], v11 offset:30720
    buffer_load_dwordx4 a[76:79], v2, s[36:39], s87 offen offset:3072 sc1
    s_waitcnt vmcnt(9)
    v_mfma_f32_32x32x16_bf16 v[96:111], v[40:43], a[168:171], v[96:111]
    ds_read_b64_tr_b16 v[54:55], v11 offset:31744
    s_waitcnt lgkmcnt(4)
    v_mfma_f32_32x32x16_bf16 v[112:127], v[44:47], a[56:59], v[112:127]
    ds_read_b64_tr_b16 v[40:41], v10 offset:32768
    buffer_load_dwordx4 a[188:191], v2, s[36:39], s88 offen offset:3072 sc1
    v_mfma_f32_32x32x16_bf16 v[128:143], v[44:47], a[168:171], v[128:143]
    ds_read_b64_tr_b16 v[42:43], v10 offset:33792
    s_waitcnt vmcnt(9) lgkmcnt(4)
    v_mfma_f32_32x32x16_bf16 v[80:95], v[48:51], a[60:63], v[80:95]
    ds_read_b64_tr_b16 v[44:45], v11 offset:32768
    s_lshl_b32 s87, s85, 12
    s_add_u32 s87, s87, s89
    s_add_u32 s88, s87, 28672
    buffer_load_dwordx4 a[80:83], v2, s[36:39], s87 offen offset:0 sc1
    s_waitcnt vmcnt(9)
    v_mfma_f32_32x32x16_bf16 v[96:111], v[48:51], a[172:175], v[96:111]
    ds_read_b64_tr_b16 v[46:47], v11 offset:33792
    s_waitcnt lgkmcnt(4)
    v_mfma_f32_32x32x16_bf16 v[112:127], v[52:55], a[60:63], v[112:127]
    ds_read_b64_tr_b16 v[48:49], v10 offset:34816
    buffer_load_dwordx4 a[192:195], v2, s[36:39], s88 offen offset:0 sc1
    v_mfma_f32_32x32x16_bf16 v[128:143], v[52:55], a[172:175], v[128:143]
    ds_read_b64_tr_b16 v[50:51], v10 offset:35840
    s_waitcnt vmcnt(9) lgkmcnt(4)
    v_mfma_f32_32x32x16_bf16 v[80:95], v[40:43], a[64:67], v[80:95]
    ds_read_b64_tr_b16 v[52:53], v11 offset:34816
    buffer_load_dwordx4 a[84:87], v2, s[36:39], s87 offen offset:1024 sc1
    s_waitcnt vmcnt(9)
    v_mfma_f32_32x32x16_bf16 v[96:111], v[40:43], a[176:179], v[96:111]
    ds_read_b64_tr_b16 v[54:55], v11 offset:35840
    s_waitcnt lgkmcnt(4)
    v_mfma_f32_32x32x16_bf16 v[112:127], v[44:47], a[64:67], v[112:127]
    ds_read_b64_tr_b16 v[40:41], v10 offset:36864
    buffer_load_dwordx4 a[196:199], v2, s[36:39], s88 offen offset:1024 sc1
    v_mfma_f32_32x32x16_bf16 v[128:143], v[44:47], a[176:179], v[128:143]
    ds_read_b64_tr_b16 v[42:43], v10 offset:37888
    s_waitcnt vmcnt(9) lgkmcnt(4)
    v_mfma_f32_32x32x16_bf16 v[80:95], v[48:51], a[68:71], v[80:95]
    ds_read_b64_tr_b16 v[44:45], v11 offset:36864
    buffer_load_dwordx4 a[88:91], v2, s[36:39], s87 offen offset:2048 sc1
    s_waitcnt vmcnt(9)
    v_mfma_f32_32x32x16_bf16 v[96:111], v[48:51], a[180:183], v[96:111]
    ds_read_b64_tr_b16 v[46:47], v11 offset:37888
    s_waitcnt lgkmcnt(4)
    v_mfma_f32_32x32x16_bf16 v[112:127], v[52:55], a[68:71], v[112:127]
    ds_read_b64_tr_b16 v[48:49], v10 offset:38912
    buffer_load_dwordx4 a[200:203], v2, s[36:39], s88 offen offset:2048 sc1
    v_mfma_f32_32x32x16_bf16 v[128:143], v[52:55], a[180:183], v[128:143]
    ds_read_b64_tr_b16 v[50:51], v10 offset:39936
    s_waitcnt vmcnt(9) lgkmcnt(4)
    v_mfma_f32_32x32x16_bf16 v[80:95], v[40:43], a[72:75], v[80:95]
    ds_read_b64_tr_b16 v[52:53], v11 offset:38912
    buffer_load_dwordx4 a[92:95], v2, s[36:39], s87 offen offset:3072 sc1
    s_waitcnt vmcnt(9)
    v_mfma_f32_32x32x16_bf16 v[96:111], v[40:43], a[184:187], v[96:111]
    ds_read_b64_tr_b16 v[54:55], v11 offset:39936
    s_waitcnt lgkmcnt(4)
    v_mfma_f32_32x32x16_bf16 v[112:127], v[44:47], a[72:75], v[112:127]
    ds_read_b64_tr_b16 v[40:41], v10 offset:40960
    buffer_load_dwordx4 a[204:207], v2, s[36:39], s88 offen offset:3072 sc1
    v_mfma_f32_32x32x16_bf16 v[128:143], v[44:47], a[184:187], v[128:143]
    ds_read_b64_tr_b16 v[42:43], v10 offset:41984
    s_waitcnt vmcnt(9) lgkmcnt(4)
    v_mfma_f32_32x32x16_bf16 v[80:95], v[48:51], a[76:79], v[80:95]
    ds_read_b64_tr_b16 v[44:45], v11 offset:40960
    s_lshl_b32 s87, s86, 12
    s_add_u32 s87, s87, s89
    s_add_u32 s88, s87, 28672
    buffer_load_dwordx4 a[96:99], v2, s[36:39], s87 offen offset:0 sc1
    s_waitcnt vmcnt(9)
    v_mfma_f32_32x32x16_bf16 v[96:111], v[48:51], a[188:191], v[96:111]
    ds_read_b64_tr_b16 v[46:47], v11 offset:41984
    s_waitcnt lgkmcnt(4)
    v_mfma_f32_32x32x16_bf16 v[112:127], v[52:55], a[76:79], v[112:127]
    ds_read_b64_tr_b16 v[48:49], v10 offset:43008
    buffer_load_dwordx4 a[208:211], v2, s[36:39], s88 offen offset:0 sc1
    v_mfma_f32_32x32x16_bf16 v[128:143], v[52:55], a[188:191], v[128:143]
    ds_read_b64_tr_b16 v[50:51], v10 offset:44032
    s_waitcnt vmcnt(9) lgkmcnt(4)
    v_mfma_f32_32x32x16_bf16 v[80:95], v[40:43], a[80:83], v[80:95]
    ds_read_b64_tr_b16 v[52:53], v11 offset:43008
    buffer_load_dwordx4 a[100:103], v2, s[36:39], s87 offen offset:1024 sc1
    s_waitcnt vmcnt(9)
    v_mfma_f32_32x32x16_bf16 v[96:111], v[40:43], a[192:195], v[96:111]
    ds_read_b64_tr_b16 v[54:55], v11 offset:44032
    s_waitcnt lgkmcnt(4)
    v_mfma_f32_32x32x16_bf16 v[112:127], v[44:47], a[80:83], v[112:127]
    ds_read_b64_tr_b16 v[40:41], v10 offset:45056
    buffer_load_dwordx4 a[212:215], v2, s[36:39], s88 offen offset:1024 sc1
    s_lshl_b32 s97, s50, 13
    s_add_u32 s97, s97, s96
    buffer_load_dwordx4 v[152:155], v38, s[36:39], s97 offen offset:0 sc1
    v_mfma_f32_32x32x16_bf16 v[128:143], v[44:47], a[192:195], v[128:143]
    ds_read_b64_tr_b16 v[42:43], v10 offset:46080
    s_waitcnt vmcnt(10) lgkmcnt(4)
    v_mfma_f32_32x32x16_bf16 v[80:95], v[48:51], a[84:87], v[80:95]
    ds_read_b64_tr_b16 v[44:45], v11 offset:45056
    buffer_load_dwordx4 a[104:107], v2, s[36:39], s87 offen offset:2048 sc1
    s_waitcnt vmcnt(10)
    v_mfma_f32_32x32x16_bf16 v[96:111], v[48:51], a[196:199], v[96:111]
    ds_read_b64_tr_b16 v[46:47], v11 offset:46080
    buffer_load_dwordx4 v[156:159], v39, s[36:39], s97 offen offset:0 sc1
    s_waitcnt lgkmcnt(4)
    v_mfma_f32_32x32x16_bf16 v[112:127], v[52:55], a[84:87], v[112:127]
    ds_read_b64_tr_b16 v[48:49], v10 offset:47104
    buffer_load_dwordx4 a[216:219], v2, s[36:39], s88 offen offset:2048 sc1
    v_mfma_f32_32x32x16_bf16 v[128:143], v[52:55], a[196:199], v[128:143]
    ds_read_b64_tr_b16 v[50:51], v10 offset:48128
    s_waitcnt vmcnt(11) lgkmcnt(4)
    v_mfma_f32_32x32x16_bf16 v[80:95], v[40:43], a[88:91], v[80:95]
    ds_read_b64_tr_b16 v[52:53], v11 offset:47104
    buffer_load_dwordx4 a[108:111], v2, s[36:39], s87 offen offset:3072 sc1
    s_lshl_b32 s97, s50, 13
    s_add_u32 s97, s97, s96
    buffer_load_dwordx4 v[160:163], v38, s[36:39], s97 offen offset:2048 sc1
    s_waitcnt vmcnt(12)
    v_mfma_f32_32x32x16_bf16 v[96:111], v[40:43], a[200:203], v[96:111]
    ds_read_b64_tr_b16 v[54:55], v11 offset:48128
    s_waitcnt lgkmcnt(4)
    v_mfma_f32_32x32x16_bf16 v[112:127], v[44:47], a[88:91], v[112:127]
    ds_read_b64_tr_b16 v[40:41], v10 offset:49152
    buffer_load_dwordx4 a[220:223], v2, s[36:39], s88 offen offset:3072 sc1
    v_mfma_f32_32x32x16_bf16 v[128:143], v[44:47], a[200:203], v[128:143]
    ds_read_b64_tr_b16 v[42:43], v10 offset:50176
    buffer_load_dwordx4 v[164:167], v39, s[36:39], s97 offen offset:2048 sc1
    s_waitcnt vmcnt(13) lgkmcnt(4)
    v_mfma_f32_32x32x16_bf16 v[80:95], v[48:51], a[92:95], v[80:95]
    ds_read_b64_tr_b16 v[44:45], v11 offset:49152
    v_max3_u32 v4, v24, v25, v26
    v_max3_u32 v5, v27, v28, v29
    v_max3_u32 v4, v4, v30, v31
    v_max_u32 v4, v4, v5
    s_waitcnt vmcnt(12)
    v_mfma_f32_32x32x16_bf16 v[96:111], v[48:51], a[204:207], v[96:111]
    ds_read_b64_tr_b16 v[46:47], v11 offset:50176
    v_cmp_eq_u32 vcc, -1, v4
    s_nop 3
    s_cbranch_vccnz Lcsslow
Lcsok:
    s_waitcnt lgkmcnt(4)
    v_mfma_f32_32x32x16_bf16 v[112:127], v[52:55], a[92:95], v[112:127]
    ds_read_b64_tr_b16 v[48:49], v10 offset:51200
    s_lshl_b32 s97, s51, 13
    s_add_u32 s97, s97, s96
    buffer_load_dwordx4 v[168:171], v38, s[36:39], s97 offen offset:0 sc1
    v_mfma_f32_32x32x16_bf16 v[128:143], v[52:55], a[204:207], v[128:143]
    ds_read_b64_tr_b16 v[50:51], v10 offset:52224
    s_waitcnt vmcnt(12) lgkmcnt(4)
    v_mfma_f32_32x32x16_bf16 v[80:95], v[40:43], a[96:99], v[80:95]
    ds_read_b64_tr_b16 v[52:53], v11 offset:51200
    s_waitcnt vmcnt(11)
    v_mfma_f32_32x32x16_bf16 v[96:111], v[40:43], a[208:211], v[96:111]
    ds_read_b64_tr_b16 v[54:55], v11 offset:52224
    buffer_load_dwordx4 v[172:175], v39, s[36:39], s97 offen offset:0 sc1
    s_waitcnt lgkmcnt(4)
    v_mfma_f32_32x32x16_bf16 v[112:127], v[44:47], a[96:99], v[112:127]
    ds_read_b64_tr_b16 v[40:41], v10 offset:53248
    v_mfma_f32_32x32x16_bf16 v[128:143], v[44:47], a[208:211], v[128:143]
    ds_read_b64_tr_b16 v[42:43], v10 offset:54272
    s_waitcnt vmcnt(11) lgkmcnt(4)
    v_mfma_f32_32x32x16_bf16 v[80:95], v[48:51], a[100:103], v[80:95]
    ds_read_b64_tr_b16 v[44:45], v11 offset:53248
    s_lshl_b32 s97, s51, 13
    s_add_u32 s97, s97, s96
    buffer_load_dwordx4 v[176:179], v38, s[36:39], s97 offen offset:2048 sc1
    s_waitcnt vmcnt(11)
    v_mfma_f32_32x32x16_bf16 v[96:111], v[48:51], a[212:215], v[96:111]
    ds_read_b64_tr_b16 v[46:47], v11 offset:54272
    s_waitcnt lgkmcnt(4)
    v_mfma_f32_32x32x16_bf16 v[112:127], v[52:55], a[100:103], v[112:127]
    ds_read_b64_tr_b16 v[48:49], v10 offset:55296
    v_mfma_f32_32x32x16_bf16 v[128:143], v[52:55], a[212:215], v[128:143]
    ds_read_b64_tr_b16 v[50:51], v10 offset:56320
    buffer_load_dwordx4 v[180:183], v39, s[36:39], s97 offen offset:2048 sc1
    s_waitcnt vmcnt(10) lgkmcnt(4)
    v_mfma_f32_32x32x16_bf16 v[80:95], v[40:43], a[104:107], v[80:95]
    ds_read_b64_tr_b16 v[52:53], v11 offset:55296
    s_waitcnt vmcnt(8)
    v_mfma_f32_32x32x16_bf16 v[96:111], v[40:43], a[216:219], v[96:111]
    ds_read_b64_tr_b16 v[54:55], v11 offset:56320
    s_waitcnt lgkmcnt(4)
    v_mfma_f32_32x32x16_bf16 v[112:127], v[44:47], a[104:107], v[112:127]
    s_lshl_b32 s97, s52, 13
    s_add_u32 s97, s97, s96
    buffer_load_dwordx4 v[184:187], v38, s[36:39], s97 offen offset:0 sc1
    v_mfma_f32_32x32x16_bf16 v[128:143], v[44:47], a[216:219], v[128:143]
    s_waitcnt vmcnt(8) lgkmcnt(2)
    v_mfma_f32_32x32x16_bf16 v[80:95], v[48:51], a[108:111], v[80:95]
    s_waitcnt vmcnt(6)
    v_mfma_f32_32x32x16_bf16 v[96:111], v[48:51], a[220:223], v[96:111]
    buffer_load_dwordx4 v[188:191], v39, s[36:39], s97 offen offset:0 sc1
    s_waitcnt lgkmcnt(0)
    v_mfma_f32_32x32x16_bf16 v[112:127], v[52:55], a[108:111], v[112:127]
    v_mfma_f32_32x32x16_bf16 v[128:143], v[52:55], a[220:223], v[128:143]
    v_mov_b32 v32, v24
    v_mov_b32 v33, v25
    s_nop 1
    v_mfma_f32_32x32x16_bf16 v[80:95], v[32:35], v[16:19], v[80:95]
    v_mfma_f32_32x32x16_bf16 v[96:111], v[32:35], v[20:23], v[96:111]
    v_mov_b32 v32, v26
    v_mov_b32 v33, v27
    s_nop 1
    v_mfma_f32_32x32x16_bf16 v[112:127], v[32:35], v[16:19], v[112:127]
    v_mfma_f32_32x32x16_bf16 v[128:143], v[32:35], v[20:23], v[128:143]
    ds_read_b64_tr_b16 v[40:41], v12 offset:0
    ds_read_b64_tr_b16 v[42:43], v12 offset:1024
    ds_read_b64_tr_b16 v[44:45], v12 offset:2048
    ds_read_b64_tr_b16 v[46:47], v12 offset:3072
    ds_read_b64_tr_b16 v[48:49], v12 offset:4096
    ds_read_b64_tr_b16 v[50:51], v12 offset:5120
    s_waitcnt lgkmcnt(4)
    v_mfma_f32_32x32x16_bf16 a[224:239], v[40:43], a[0:3], 0
    ds_read_b64_tr_b16 v[52:53], v12 offset:6144
    v_mfma_f32_32x32x16_bf16 a[240:255], v[40:43], a[112:115], 0
    ds_read_b64_tr_b16 v[54:55], v12 offset:7168
    s_waitcnt lgkmcnt(4)
    v_mfma_f32_32x32x16_bf16 a[224:239], v[44:47], a[4:7], a[224:239]
    ds_read_b64_tr_b16 v[40:41], v12 offset:8192
    v_cmp_u_f32 vcc, v80, v96
    s_nop 3
    s_cbranch_vccz Lok16
    s_cmp_eq_u32 s93, 0
    s_cbranch_scc1 Lslow
Lok16:
    s_mul_i32 s87, s78, 229376
    v_mfma_f32_32x32x16_bf16 a[240:255], v[44:47], a[116:119], a[240:255]
    ds_read_b64_tr_b16 v[42:43], v12 offset:9216
    s_lshl_b32 s97, s52, 13
    s_add_u32 s97, s97, s96
    buffer_load_dwordx4 v[192:195], v38, s[36:39], s97 offen offset:2048 sc1
    s_lshl_b32 s88, s77, 12
    s_add_u32 s87, s87, s88
    s_add_u32 s87, s87, 9437184
    s_add_u32 s88, s87, 114688
    v_mul_f32 v56, v36, v80
    s_waitcnt lgkmcnt(4)
    v_mfma_f32_32x32x16_bf16 a[224:239], v[48:51], a[8:11], a[224:239]
    ds_read_b64_tr_b16 v[44:45], v12 offset:10240
    v_mul_f32 v57, v36, v81
    v_mul_f32 v58, v36, v82
    v_mul_f32 v59, v36, v83
    v_mul_f32 v60, v36, v84
    v_mul_f32 v61, v36, v85
    v_mfma_f32_32x32x16_bf16 a[240:255], v[48:51], a[120:123], a[240:255]
    ds_read_b64_tr_b16 v[46:47], v12 offset:11264
    buffer_load_dwordx4 v[196:199], v39, s[36:39], s97 offen offset:2048 sc1
    v_mul_f32 v62, v36, v86
    v_mul_f32 v63, v36, v87
    v_exp_f32 v56, v56
    v_exp_f32 v57, v57
    s_waitcnt lgkmcnt(4)
    v_mfma_f32_32x32x16_bf16 a[224:239], v[52:55], a[12:15], a[224:239]
    ds_read_b64_tr_b16 v[48:49], v12 offset:12288
    v_exp_f32 v58, v58
    v_exp_f32 v59, v59
    v_mfma_f32_32x32x16_bf16 a[240:255], v[52:55], a[124:127], a[240:255]
    ds_read_b64_tr_b16 v[50:51], v12 offset:13312
    v_exp_f32 v60, v60
    v_exp_f32 v61, v61
    s_waitcnt lgkmcnt(4)
    v_mfma_f32_32x32x16_bf16 a[224:239], v[40:43], a[16:19], a[224:239]
    ds_read_b64_tr_b16 v[52:53], v12 offset:14336
    s_lshl_b32 s97, s53, 13
    s_add_u32 s97, s97, s96
    buffer_load_dwordx4 v[200:203], v38, s[36:39], s97 offen offset:0 sc1
    v_exp_f32 v62, v62
    v_exp_f32 v63, v63
    v_add_f32 v56, 1.0, v56
    v_mfma_f32_32x32x16_bf16 a[240:255], v[40:43], a[128:131], a[240:255]
    ds_read_b64_tr_b16 v[54:55], v12 offset:15360
    v_add_f32 v57, 1.0, v57
    v_add_f32 v58, 1.0, v58
    v_add_f32 v59, 1.0, v59
    v_add_f32 v60, 1.0, v60
    v_add_f32 v61, 1.0, v61
    s_waitcnt lgkmcnt(4)
    v_mfma_f32_32x32x16_bf16 a[224:239], v[44:47], a[20:23], a[224:239]
    ds_read_b64_tr_b16 v[40:41], v12 offset:16384
    v_add_f32 v62, 1.0, v62
    v_add_f32 v63, 1.0, v63
    v_rcp_f32 v56, v56
    v_mfma_f32_32x32x16_bf16 a[240:255], v[44:47], a[132:135], a[240:255]
    ds_read_b64_tr_b16 v[42:43], v12 offset:17408
    buffer_load_dwordx4 v[204:207], v39, s[36:39], s97 offen offset:0 sc1
    v_rcp_f32 v57, v57
    v_rcp_f32 v58, v58
    v_rcp_f32 v59, v59
    s_waitcnt lgkmcnt(4)
    v_mfma_f32_32x32x16_bf16 a[224:239], v[48:51], a[24:27], a[224:239]
    ds_read_b64_tr_b16 v[44:45], v12 offset:18432
    v_rcp_f32 v60, v60
    v_rcp_f32 v61, v61
    v_mfma_f32_32x32x16_bf16 a[240:255], v[48:51], a[136:139], a[240:255]
    ds_read_b64_tr_b16 v[46:47], v12 offset:19456
    v_rcp_f32 v62, v62
    v_rcp_f32 v63, v63
    v_mul_f32 v56, v56, v88
    s_waitcnt lgkmcnt(4)
    v_mfma_f32_32x32x16_bf16 a[224:239], v[52:55], a[28:31], a[224:239]
    ds_read_b64_tr_b16 v[48:49], v12 offset:20480
    s_lshl_b32 s97, s53, 13
    s_add_u32 s97, s97, s96
    buffer_load_dwordx4 v[208:211], v38, s[36:39], s97 offen offset:2048 sc1
    v_mul_f32 v57, v57, v89
    v_mul_f32 v58, v58, v90
    v_mul_f32 v59, v59, v91
    v_mul_f32 v60, v60, v92
    v_mfma_f32_32x32x16_bf16 a[240:255], v[52:55], a[140:143], a[240:255]
    ds_read_b64_tr_b16 v[50:51], v12 offset:21504
    v_mul_f32 v61, v61, v93
    v_mul_f32 v62, v62, v94
    v_mul_f32 v63, v63, v95
    v_cvt_pk_bf16_f32 v72, v56, v57
    v_cvt_pk_bf16_f32 v73, v58, v59
    s_waitcnt lgkmcnt(4)
    v_mfma_f32_32x32x16_bf16 a[224:239], v[40:43], a[32:35], a[224:239]
    ds_read_b64_tr_b16 v[52:53], v12 offset:22528
    buffer_load_dwordx4 v[212:215], v39, s[36:39], s97 offen offset:2048 sc1
    v_cvt_pk_bf16_f32 v74, v60, v61
    v_cvt_pk_bf16_f32 v75, v62, v63
    v_mul_f32 v64, v37, v96
    v_mul_f32 v65, v37, v97
    v_mfma_f32_32x32x16_bf16 a[240:255], v[40:43], a[144:147], a[240:255]
    ds_read_b64_tr_b16 v[54:55], v12 offset:23552
    v_mul_f32 v66, v37, v98
    v_mul_f32 v67, v37, v99
    v_mul_f32 v68, v37, v100
    v_mul_f32 v69, v37, v101
    v_mul_f32 v70, v37, v102
    s_waitcnt lgkmcnt(4)
    v_mfma_f32_32x32x16_bf16 a[224:239], v[44:47], a[36:39], a[224:239]
    ds_read_b64_tr_b16 v[40:41], v12 offset:24576
    v_mul_f32 v71, v37, v103
    v_exp_f32 v64, v64
    v_exp_f32 v65, v65
    v_mfma_f32_32x32x16_bf16 a[240:255], v[44:47], a[148:151], a[240:255]
    ds_read_b64_tr_b16 v[42:43], v12 offset:25600
    s_lshl_b32 s97, s54, 13
    s_add_u32 s97, s97, s96
    buffer_load_dwordx4 v[216:219], v38, s[36:39], s97 offen offset:0 sc1
    v_exp_f32 v66, v66
    v_exp_f32 v67, v67
    s_waitcnt lgkmcnt(4)
    v_mfma_f32_32x32x16_bf16 a[224:239], v[48:51], a[40:43], a[224:239]
    ds_read_b64_tr_b16 v[44:45], v12 offset:26624
    v_exp_f32 v68, v68
    v_exp_f32 v69, v69
    v_exp_f32 v70, v70
    v_mfma_f32_32x32x16_bf16 a[240:255], v[48:51], a[152:155], a[240:255]
    ds_read_b64_tr_b16 v[46:47], v12 offset:27648
    v_exp_f32 v71, v71
    v_add_f32 v64, 1.0, v64
    v_add_f32 v65, 1.0, v65
    s_waitcnt lgkmcnt(4)
    v_mfma_f32_32x32x16_bf16 a[224:239], v[52:55], a[44:47], a[224:239]
    ds_read_b64_tr_b16 v[48:49], v12 offset:28672
    buffer_load_dwordx4 v[220:223], v39, s[36:39], s97 offen offset:0 sc1
    v_add_f32 v66, 1.0, v66
    v_add_f32 v67, 1.0, v67
    v_add_f32 v68, 1.0, v68
    v_add_f32 v69, 1.0, v69
    v_add_f32 v70, 1.0, v70
    v_mfma_f32_32x32x16_bf16 a[240:255], v[52:55], a[156:159], a[240:255]
    ds_read_b64_tr_b16 v[50:51], v12 offset:29696
    v_add_f32 v71, 1.0, v71
    v_rcp_f32 v64, v64
    v_rcp_f32 v65, v65
    s_waitcnt lgkmcnt(4)
    v_mfma_f32_32x32x16_bf16 a[224:239], v[40:43], a[48:51], a[224:239]
    ds_read_b64_tr_b16 v[52:53], v12 offset:30720
    v_rcp_f32 v66, v66
    v_rcp_f32 v67, v67
    v_mfma_f32_32x32x16_bf16 a[240:255], v[40:43], a[160:163], a[240:255]
    ds_read_b64_tr_b16 v[54:55], v12 offset:31744
    s_lshl_b32 s97, s54, 13
    s_add_u32 s97, s97, s96
    buffer_load_dwordx4 v[224:227], v38, s[36:39], s97 offen offset:2048 sc1
    v_rcp_f32 v68, v68
    v_rcp_f32 v69, v69
    v_rcp_f32 v70, v70
    s_waitcnt lgkmcnt(4)
    v_mfma_f32_32x32x16_bf16 a[224:239], v[44:47], a[52:55], a[224:239]
    ds_read_b64_tr_b16 v[40:41], v12 offset:32768
    v_rcp_f32 v71, v71
    v_mul_f32 v64, v64, v104
    v_mul_f32 v65, v65, v105
    v_mfma_f32_32x32x16_bf16 a[240:255], v[44:47], a[164:167], a[240:255]
    ds_read_b64_tr_b16 v[42:43], v12 offset:33792
    buffer_load_dwordx4 v[228:231], v39, s[36:39], s97 offen offset:2048 sc1
    v_mul_f32 v66, v66, v106
    v_mul_f32 v67, v67, v107
    v_mul_f32 v68, v68, v108
    v_mul_f32 v69, v69, v109
    s_waitcnt lgkmcnt(4)
    v_mfma_f32_32x32x16_bf16 a[224:239], v[48:51], a[56:59], a[224:239]
    ds_read_b64_tr_b16 v[44:45], v12 offset:34816
    v_mul_f32 v70, v70, v110
    v_mul_f32 v71, v71, v111
    v_cvt_pk_bf16_f32 v76, v64, v65
    v_cvt_pk_bf16_f32 v77, v66, v67
    v_cvt_pk_bf16_f32 v78, v68, v69
    v_mfma_f32_32x32x16_bf16 a[240:255], v[48:51], a[168:171], a[240:255]
    ds_read_b64_tr_b16 v[46:47], v12 offset:35840
    v_cvt_pk_bf16_f32 v79, v70, v71
    buffer_store_dwordx4 v[72:75], v2, s[36:39], s87 offen offset:0 sc1
    buffer_store_dwordx4 v[76:79], v2, s[36:39], s88 offen offset:0 sc1
    s_waitcnt lgkmcnt(4)
    v_mfma_f32_32x32x16_bf16 a[224:239], v[52:55], a[60:63], a[224:239]
    ds_read_b64_tr_b16 v[48:49], v12 offset:36864
    s_lshl_b32 s97, s55, 13
    s_add_u32 s97, s97, s96
    buffer_load_dwordx4 v[232:235], v38, s[36:39], s97 offen offset:0 sc1
    v_mul_f32 v56, v36, v112
    v_mul_f32 v57, v36, v113
    v_mul_f32 v58, v36, v114
    v_mul_f32 v59, v36, v115
    v_mul_f32 v60, v36, v116
    v_mfma_f32_32x32x16_bf16 a[240:255], v[52:55], a[172:175], a[240:255]
    ds_read_b64_tr_b16 v[50:51], v12 offset:37888
    v_mul_f32 v61, v36, v117
    v_mul_f32 v62, v36, v118
    v_mul_f32 v63, v36, v119
    v_exp_f32 v56, v56
    s_waitcnt lgkmcnt(4)
    v_mfma_f32_32x32x16_bf16 a[224:239], v[40:43], a[64:67], a[224:239]
    ds_read_b64_tr_b16 v[52:53], v12 offset:38912
    v_exp_f32 v57, v57
    v_exp_f32 v58, v58
    v_exp_f32 v59, v59
    v_mfma_f32_32x32x16_bf16 a[240:255], v[40:43], a[176:179], a[240:255]
    ds_read_b64_tr_b16 v[54:55], v12 offset:39936
    buffer_load_dwordx4 v[236:239], v39, s[36:39], s97 offen offset:0 sc1
    v_exp_f32 v60, v60
    v_exp_f32 v61, v61
    s_waitcnt lgkmcnt(4)
    v_mfma_f32_32x32x16_bf16 a[224:239], v[44:47], a[68:71], a[224:239]
    ds_read_b64_tr_b16 v[40:41], v12 offset:40960
    v_exp_f32 v62, v62
    v_exp_f32 v63, v63
    v_mfma_f32_32x32x16_bf16 a[240:255], v[44:47], a[180:183], a[240:255]
    ds_read_b64_tr_b16 v[42:43], v12 offset:41984
    v_add_f32 v56, 1.0, v56
    v_add_f32 v57, 1.0, v57
    v_add_f32 v58, 1.0, v58
    v_add_f32 v59, 1.0, v59
    v_add_f32 v60, 1.0, v60
    s_waitcnt lgkmcnt(4)
    v_mfma_f32_32x32x16_bf16 a[224:239], v[48:51], a[72:75], a[224:239]
    ds_read_b64_tr_b16 v[44:45], v12 offset:43008
    s_lshl_b32 s97, s55, 13
    s_add_u32 s97, s97, s96
    buffer_load_dwordx4 v[240:243], v38, s[36:39], s97 offen offset:2048 sc1
    v_add_f32 v61, 1.0, v61
    v_add_f32 v62, 1.0, v62
    v_add_f32 v63, 1.0, v63
    v_rcp_f32 v56, v56
    v_mfma_f32_32x32x16_bf16 a[240:255], v[48:51], a[184:187], a[240:255]
    ds_read_b64_tr_b16 v[46:47], v12 offset:44032
    v_rcp_f32 v57, v57
    v_rcp_f32 v58, v58
    v_rcp_f32 v59, v59
    s_waitcnt lgkmcnt(4)
    v_mfma_f32_32x32x16_bf16 a[224:239], v[52:55], a[76:79], a[224:239]
    ds_read_b64_tr_b16 v[48:49], v12 offset:45056
    buffer_load_dwordx4 v[244:247], v39, s[36:39], s97 offen offset:2048 sc1
    v_rcp_f32 v60, v60
    v_rcp_f32 v61, v61
    v_mfma_f32_32x32x16_bf16 a[240:255], v[52:55], a[188:191], a[240:255]
    ds_read_b64_tr_b16 v[50:51], v12 offset:46080
    v_rcp_f32 v62, v62
    v_rcp_f32 v63, v63
    s_waitcnt lgkmcnt(4)
    v_mfma_f32_32x32x16_bf16 a[224:239], v[40:43], a[80:83], a[224:239]
    ds_read_b64_tr_b16 v[52:53], v12 offset:47104
    v_mul_f32 v56, v56, v120
    v_mul_f32 v57, v57, v121
    v_mul_f32 v58, v58, v122
    v_mul_f32 v59, v59, v123
    v_mul_f32 v60, v60, v124
    v_mfma_f32_32x32x16_bf16 a[240:255], v[40:43], a[192:195], a[240:255]
    ds_read_b64_tr_b16 v[54:55], v12 offset:48128
    s_lshl_b32 s97, s56, 13
    s_add_u32 s97, s97, s96
    buffer_load_dwordx4 v[248:251], v38, s[36:39], s97 offen offset:0 sc1
    v_mul_f32 v61, v61, v125
    v_mul_f32 v62, v62, v126
    v_mul_f32 v63, v63, v127
    v_cvt_pk_bf16_f32 v80, v56, v57
    s_waitcnt lgkmcnt(4)
    v_mfma_f32_32x32x16_bf16 a[224:239], v[44:47], a[84:87], a[224:239]
    ds_read_b64_tr_b16 v[40:41], v12 offset:49152
    v_cvt_pk_bf16_f32 v81, v58, v59
    v_cvt_pk_bf16_f32 v82, v60, v61
    v_cvt_pk_bf16_f32 v83, v62, v63
    v_mul_f32 v64, v37, v128
    v_mfma_f32_32x32x16_bf16 a[240:255], v[44:47], a[196:199], a[240:255]
    ds_read_b64_tr_b16 v[42:43], v12 offset:50176
    v_mul_f32 v65, v37, v129
    v_mul_f32 v66, v37, v130
    v_mul_f32 v67, v37, v131
    v_mul_f32 v68, v37, v132
    v_mul_f32 v69, v37, v133
    s_waitcnt lgkmcnt(4)
    v_mfma_f32_32x32x16_bf16 a[224:239], v[48:51], a[88:91], a[224:239]
    ds_read_b64_tr_b16 v[44:45], v12 offset:51200
    buffer_load_dwordx4 v[252:255], v39, s[36:39], s97 offen offset:0 sc1
    v_mul_f32 v70, v37, v134
    v_mul_f32 v71, v37, v135
    v_exp_f32 v64, v64
    v_exp_f32 v65, v65
    v_mfma_f32_32x32x16_bf16 a[240:255], v[48:51], a[200:203], a[240:255]
    ds_read_b64_tr_b16 v[46:47], v12 offset:52224
    v_exp_f32 v66, v66
    v_exp_f32 v67, v67
    s_waitcnt lgkmcnt(4)
    v_mfma_f32_32x32x16_bf16 a[224:239], v[52:55], a[92:95], a[224:239]
    ds_read_b64_tr_b16 v[48:49], v12 offset:53248
    v_exp_f32 v68, v68
    v_exp_f32 v69, v69
    v_mfma_f32_32x32x16_bf16 a[240:255], v[52:55], a[204:207], a[240:255]
    ds_read_b64_tr_b16 v[50:51], v12 offset:54272
    v_exp_f32 v70, v70
    v_exp_f32 v71, v71
    v_add_f32 v64, 1.0, v64
    s_waitcnt lgkmcnt(4)
    v_mfma_f32_32x32x16_bf16 a[224:239], v[40:43], a[96:99], a[224:239]
    ds_read_b64_tr_b16 v[52:53], v12 offset:55296
    v_add_f32 v65, 1.0, v65
    v_add_f32 v66, 1.0, v66
    v_add_f32 v67, 1.0, v67
    v_add_f32 v68, 1.0, v68
    v_add_f32 v69, 1.0, v69
    v_mfma_f32_32x32x16_bf16 a[240:255], v[40:43], a[208:211], a[240:255]
    ds_read_b64_tr_b16 v[54:55], v12 offset:56320
    v_add_f32 v70, 1.0, v70
    v_add_f32 v71, 1.0, v71
    v_rcp_f32 v64, v64
    v_rcp_f32 v65, v65
    s_waitcnt lgkmcnt(4)
    v_mfma_f32_32x32x16_bf16 a[224:239], v[44:47], a[100:103], a[224:239]
    v_rcp_f32 v66, v66
    v_rcp_f32 v67, v67
    v_rcp_f32 v68, v68
    v_mfma_f32_32x32x16_bf16 a[240:255], v[44:47], a[212:215], a[240:255]
    v_rcp_f32 v69, v69
    v_rcp_f32 v70, v70
    v_rcp_f32 v71, v71
    s_waitcnt lgkmcnt(2)
    v_mfma_f32_32x32x16_bf16 a[224:239], v[48:51], a[104:107], a[224:239]
    v_mul_f32 v64, v64, v136
    v_mul_f32 v65, v65, v137
    v_mul_f32 v66, v66, v138
    v_mul_f32 v67, v67, v139
    v_mul_f32 v68, v68, v140
    v_mfma_f32_32x32x16_bf16 a[240:255], v[48:51], a[216:219], a[240:255]
    v_mul_f32 v69, v69, v141
    v_mul_f32 v70, v70, v142
    v_mul_f32 v71, v71, v143
    v_cvt_pk_bf16_f32 v84, v64, v65
    v_cvt_pk_bf16_f32 v85, v66, v67
    s_waitcnt lgkmcnt(0)
    v_mfma_f32_32x32x16_bf16 a[224:239], v[52:55], a[108:111], a[224:239]
    v_cvt_pk_bf16_f32 v86, v68, v69
    v_cvt_pk_bf16_f32 v87, v70, v71
    buffer_store_dwordx4 v[80:83], v2, s[36:39], s87 offen offset:1024 sc1
    buffer_store_dwordx4 v[84:87], v2, s[36:39], s88 offen offset:1024 sc1
    v_mfma_f32_32x32x16_bf16 a[240:255], v[52:55], a[220:223], a[240:255]
    v_mov_b32 v32, v28
    v_mov_b32 v33, v29
    s_nop 1
    v_mfma_f32_32x32x16_bf16 a[224:239], v[32:35], v[16:19], a[224:239]
    v_mfma_f32_32x32x16_bf16 a[240:255], v[32:35], v[20:23], a[240:255]
    ds_read_b64_tr_b16 v[40:41], v13 offset:0
    ds_read_b64_tr_b16 v[42:43], v13 offset:1024
    ds_read_b64_tr_b16 v[44:45], v13 offset:2048
    ds_read_b64_tr_b16 v[46:47], v13 offset:3072
    ds_read_b64_tr_b16 v[48:49], v13 offset:4096
    ds_read_b64_tr_b16 v[50:51], v13 offset:5120
    s_waitcnt lgkmcnt(4)
    v_mfma_f32_32x32x16_bf16 v[80:95], v[40:43], a[0:3], 0
    ds_read_b64_tr_b16 v[52:53], v13 offset:6144
    v_mfma_f32_32x32x16_bf16 v[96:111], v[40:43], a[112:115], 0
    ds_read_b64_tr_b16 v[54:55], v13 offset:7168
    s_waitcnt lgkmcnt(4)
    v_mfma_f32_32x32x16_bf16 v[80:95], v[44:47], a[4:7], v[80:95]
    ds_read_b64_tr_b16 v[40:41], v13 offset:8192
    s_lshl_b32 s97, s56, 13
    s_add_u32 s97, s97, s96
    buffer_load_dwordx4 a[0:3], v38, s[36:39], s97 offen offset:2048 sc1
    v_mfma_f32_32x32x16_bf16 v[96:111], v[44:47], a[116:119], v[96:111]
    ds_read_b64_tr_b16 v[42:43], v13 offset:9216
    v_accvgpr_read_b32 v56, a224
    v_accvgpr_read_b32 v57, a225
    v_accvgpr_read_b32 v58, a226
    v_accvgpr_read_b32 v59, a227
    s_waitcnt lgkmcnt(4)
    v_mfma_f32_32x32x16_bf16 v[80:95], v[48:51], a[8:11], v[80:95]
    ds_read_b64_tr_b16 v[44:45], v13 offset:10240
    buffer_load_dwordx4 a[112:115], v39, s[36:39], s97 offen offset:2048 sc1
    s_lshl3_add_u32 s73, s43, s42
    v_accvgpr_read_b32 v60, a228
    v_accvgpr_read_b32 v61, a229
    v_mfma_f32_32x32x16_bf16 v[96:111], v[48:51], a[120:123], v[96:111]
    ds_read_b64_tr_b16 v[46:47], v13 offset:11264
    v_accvgpr_read_b32 v62, a230
    v_accvgpr_read_b32 v63, a231
    s_lshl_b32 s73, s73, 7
    v_mul_f32 v56, v36, v56
    s_waitcnt lgkmcnt(4)
    v_mfma_f32_32x32x16_bf16 v[80:95], v[52:55], a[12:15], v[80:95]
    ds_read_b64_tr_b16 v[48:49], v13 offset:12288
    s_lshl_b32 s97, s50, 13
    s_add_u32 s97, s97, s96
    s_add_u32 s97, s97, 4096
    buffer_load_dwordx4 a[4:7], v38, s[36:39], s97 offen offset:0 sc1
    v_mul_f32 v57, v36, v57
    v_mul_f32 v58, v36, v58
    v_mul_f32 v59, v36, v59
    v_mul_f32 v60, v36, v60
    v_mfma_f32_32x32x16_bf16 v[96:111], v[52:55], a[124:127], v[96:111]
    ds_read_b64_tr_b16 v[50:51], v13 offset:13312
    v_mul_f32 v61, v36, v61
    v_mul_f32 v62, v36, v62
    v_mul_f32 v63, v36, v63
    v_exp_f32 v56, v56
    s_waitcnt lgkmcnt(4)
    v_mfma_f32_32x32x16_bf16 v[80:95], v[40:43], a[16:19], v[80:95]
    ds_read_b64_tr_b16 v[52:53], v13 offset:14336
    buffer_load_dwordx4 a[116:119], v39, s[36:39], s97 offen offset:0 sc1
    s_add_u32 s73, s73, 8913024
    v_exp_f32 v57, v57
    v_mfma_f32_32x32x16_bf16 v[96:111], v[40:43], a[128:131], v[96:111]
    ds_read_b64_tr_b16 v[54:55], v13 offset:15360
    v_exp_f32 v58, v58
    v_exp_f32 v59, v59
    v_exp_f32 v60, v60
    s_waitcnt lgkmcnt(4)
    v_mfma_f32_32x32x16_bf16 v[80:95], v[44:47], a[20:23], v[80:95]
    ds_read_b64_tr_b16 v[40:41], v13 offset:16384
    s_lshl_b32 s97, s51, 13
    s_add_u32 s97, s97, s96
    s_add_u32 s97, s97, 4096
    buffer_load_dwordx4 a[8:11], v38, s[36:39], s97 offen offset:0 sc1
    v_exp_f32 v61, v61
    v_mfma_f32_32x32x16_bf16 v[96:111], v[44:47], a[132:135], v[96:111]
    ds_read_b64_tr_b16 v[42:43], v13 offset:17408
    s_mul_i32 s89, s58, 114688
    v_exp_f32 v62, v62
    v_exp_f32 v63, v63
    s_waitcnt lgkmcnt(4)
    v_mfma_f32_32x32x16_bf16 v[80:95], v[48:51], a[24:27], v[80:95]
    ds_read_b64_tr_b16 v[44:45], v13 offset:18432
    buffer_load_dwordx4 a[120:123], v39, s[36:39], s97 offen offset:0 sc1
    v_add_f32 v56, 1.0, v56
    v_add_f32 v57, 1.0, v57
    v_add_f32 v58, 1.0, v58
    v_add_f32 v59, 1.0, v59
    v_mfma_f32_32x32x16_bf16 v[96:111], v[48:51], a[136:139], v[96:111]
    ds_read_b64_tr_b16 v[46:47], v13 offset:19456
    v_add_f32 v60, 1.0, v60
    v_add_f32 v61, 1.0, v61
    s_mul_i32 s46, s42, 28672
    v_add_f32 v62, 1.0, v62
    s_waitcnt lgkmcnt(4)
    v_mfma_f32_32x32x16_bf16 v[80:95], v[52:55], a[28:31], v[80:95]
    ds_read_b64_tr_b16 v[48:49], v13 offset:20480
    s_lshl_b32 s97, s52, 13
    s_add_u32 s97, s97, s96
    s_add_u32 s97, s97, 4096
    buffer_load_dwordx4 a[12:15], v38, s[36:39], s97 offen offset:0 sc1
    v_add_f32 v63, 1.0, v63
    v_rcp_f32 v56, v56
    v_rcp_f32 v57, v57
    v_mfma_f32_32x32x16_bf16 v[96:111], v[52:55], a[140:143], v[96:111]
    ds_read_b64_tr_b16 v[50:51], v13 offset:21504
    v_rcp_f32 v58, v58
    v_rcp_f32 v59, v59
    s_waitcnt lgkmcnt(4)
    v_mfma_f32_32x32x16_bf16 v[80:95], v[40:43], a[32:35], v[80:95]
    ds_read_b64_tr_b16 v[52:53], v13 offset:22528
    buffer_load_dwordx4 a[124:127], v39, s[36:39], s97 offen offset:0 sc1
    s_add_u32 s46, s46, 9437184
    v_rcp_f32 v60, v60
    v_mfma_f32_32x32x16_bf16 v[96:111], v[40:43], a[144:147], v[96:111]
    ds_read_b64_tr_b16 v[54:55], v13 offset:23552
    v_rcp_f32 v61, v61
    v_rcp_f32 v62, v62
    v_rcp_f32 v63, v63
    s_waitcnt lgkmcnt(4)
    v_mfma_f32_32x32x16_bf16 v[80:95], v[44:47], a[36:39], v[80:95]
    ds_read_b64_tr_b16 v[40:41], v13 offset:24576
    s_lshl_b32 s97, s53, 13
    s_add_u32 s97, s97, s96
    s_add_u32 s97, s97, 4096
    buffer_load_dwordx4 a[16:19], v38, s[36:39], s97 offen offset:0 sc1
    v_accvgpr_read_b32 v4, a232
    v_mul_f32 v56, v56, v4
    v_mfma_f32_32x32x16_bf16 v[96:111], v[44:47], a[148:151], v[96:111]
    ds_read_b64_tr_b16 v[42:43], v13 offset:25600
    s_add_u32 s89, s89, s46
    v_accvgpr_read_b32 v5, a233
    v_mul_f32 v57, v57, v5
    v_accvgpr_read_b32 v6, a234
    v_mul_f32 v58, v58, v6
    s_waitcnt lgkmcnt(4)
    v_mfma_f32_32x32x16_bf16 v[80:95], v[48:51], a[40:43], v[80:95]
    ds_read_b64_tr_b16 v[44:45], v13 offset:26624
    buffer_load_dwordx4 a[128:131], v39, s[36:39], s97 offen offset:0 sc1
    v_accvgpr_read_b32 v7, a235
    v_mul_f32 v59, v59, v7
    v_mfma_f32_32x32x16_bf16 v[96:111], v[48:51], a[152:155], v[96:111]
    ds_read_b64_tr_b16 v[46:47], v13 offset:27648
    v_accvgpr_read_b32 v4, a236
    v_mul_f32 v60, v60, v4
    s_mul_i32 s90, s75, 114688
    v_accvgpr_read_b32 v5, a237
    v_mul_f32 v61, v61, v5
    s_waitcnt lgkmcnt(4)
    v_mfma_f32_32x32x16_bf16 v[80:95], v[52:55], a[44:47], v[80:95]
    ds_read_b64_tr_b16 v[48:49], v13 offset:28672
    s_lshl_b32 s97, s54, 13
    s_add_u32 s97, s97, s96
    s_add_u32 s97, s97, 4096
    buffer_load_dwordx4 a[20:23], v38, s[36:39], s97 offen offset:0 sc1
    v_accvgpr_read_b32 v6, a238
    v_mul_f32 v62, v62, v6
    v_mfma_f32_32x32x16_bf16 v[96:111], v[52:55], a[156:159], v[96:111]
    ds_read_b64_tr_b16 v[50:51], v13 offset:29696
    v_accvgpr_read_b32 v7, a239
    v_mul_f32 v63, v63, v7
    v_cvt_pk_bf16_f32 v72, v56, v57
    v_cvt_pk_bf16_f32 v73, v58, v59
    s_waitcnt lgkmcnt(4)
    v_mfma_f32_32x32x16_bf16 v[80:95], v[40:43], a[48:51], v[80:95]
    ds_read_b64_tr_b16 v[52:53], v13 offset:30720
    buffer_load_dwordx4 a[132:135], v39, s[36:39], s97 offen offset:0 sc1
    v_cvt_pk_bf16_f32 v74, v60, v61
    s_add_u32 s90, s90, s46
    v_cvt_pk_bf16_f32 v75, v62, v63
    v_mfma_f32_32x32x16_bf16 v[96:111], v[40:43], a[160:163], v[96:111]
    ds_read_b64_tr_b16 v[54:55], v13 offset:31744
    v_accvgpr_read_b32 v64, a240
    v_accvgpr_read_b32 v65, a241
    v_accvgpr_read_b32 v66, a242
    v_accvgpr_read_b32 v67, a243
    s_waitcnt lgkmcnt(4)
    v_mfma_f32_32x32x16_bf16 v[80:95], v[44:47], a[52:55], v[80:95]
    ds_read_b64_tr_b16 v[40:41], v13 offset:32768
    s_lshl_b32 s97, s55, 13
    s_add_u32 s97, s97, s96
    s_add_u32 s97, s97, 4096
    buffer_load_dwordx4 a[24:27], v38, s[36:39], s97 offen offset:0 sc1
    v_accvgpr_read_b32 v68, a244
    v_accvgpr_read_b32 v69, a245
    v_mfma_f32_32x32x16_bf16 v[96:111], v[44:47], a[164:167], v[96:111]
    ds_read_b64_tr_b16 v[42:43], v13 offset:33792
    v_accvgpr_read_b32 v70, a246
    s_waitcnt vmcnt(13)
    s_mul_i32 s46, s77, 37
    s_lshr_b32 s46, s46, 8
    s_lshl3_add_u32 s46, s78, s46
    s_lshl_b32 s46, s46, 7
    s_add_u32 s74, s46, 8913024
    s_mov_b32 s45, 1
    s_atomic_add s45, s[36:37], s74
    s_waitcnt lgkmcnt(4)
    v_mfma_f32_32x32x16_bf16 v[80:95], v[48:51], a[56:59], v[80:95]
    ds_read_b64_tr_b16 v[44:45], v13 offset:34816
    buffer_load_dwordx4 a[136:139], v39, s[36:39], s97 offen offset:0 sc1
    v_mfma_f32_32x32x16_bf16 v[96:111], v[48:51], a[168:171], v[96:111]
    ds_read_b64_tr_b16 v[46:47], v13 offset:35840
    v_accvgpr_read_b32 v71, a247
    v_mul_f32 v64, v37, v64
    v_mul_f32 v65, v37, v65
    v_mul_f32 v66, v37, v66
    v_mul_f32 v67, v37, v67
    s_waitcnt lgkmcnt(4)
    v_mfma_f32_32x32x16_bf16 v[80:95], v[52:55], a[60:63], v[80:95]
    ds_read_b64_tr_b16 v[48:49], v13 offset:36864
    s_lshl_b32 s97, s56, 13
    s_add_u32 s97, s97, s96
    s_add_u32 s97, s97, 4096
    buffer_load_dwordx4 a[28:31], v38, s[36:39], s97 offen offset:0 sc1
    v_mul_f32 v68, v37, v68
    v_mul_f32 v69, v37, v69
    v_mul_f32 v70, v37, v70
    v_mfma_f32_32x32x16_bf16 v[96:111], v[52:55], a[172:175], v[96:111]
    ds_read_b64_tr_b16 v[50:51], v13 offset:37888
    v_mul_f32 v71, v37, v71
    v_exp_f32 v64, v64
    v_exp_f32 v65, v65
    s_waitcnt lgkmcnt(4)
    v_mfma_f32_32x32x16_bf16 v[80:95], v[40:43], a[64:67], v[80:95]
    ds_read_b64_tr_b16 v[52:53], v13 offset:38912
    buffer_load_dwordx4 a[140:143], v39, s[36:39], s97 offen offset:0 sc1
    v_exp_f32 v66, v66
    v_exp_f32 v67, v67
    v_mfma_f32_32x32x16_bf16 v[96:111], v[40:43], a[176:179], v[96:111]
    ds_read_b64_tr_b16 v[54:55], v13 offset:39936
    v_exp_f32 v68, v68
    v_exp_f32 v69, v69
    s_waitcnt lgkmcnt(4)
    v_mfma_f32_32x32x16_bf16 v[80:95], v[44:47], a[68:71], v[80:95]
    ds_read_b64_tr_b16 v[40:41], v13 offset:40960
    s_lshl_b32 s97, s50, 13
    s_add_u32 s97, s97, s96
    s_add_u32 s97, s97, 4096
    buffer_load_dwordx4 a[32:35], v38, s[36:39], s97 offen offset:2048 sc1
    v_exp_f32 v70, v70
    v_mfma_f32_32x32x16_bf16 v[96:111], v[44:47], a[180:183], v[96:111]
    ds_read_b64_tr_b16 v[42:43], v13 offset:41984
    v_exp_f32 v71, v71
    v_add_f32 v64, 1.0, v64
    v_add_f32 v65, 1.0, v65
    v_add_f32 v66, 1.0, v66
    s_waitcnt lgkmcnt(4)
    v_mfma_f32_32x32x16_bf16 v[80:95], v[48:51], a[72:75], v[80:95]
    ds_read_b64_tr_b16 v[44:45], v13 offset:43008
    buffer_load_dwordx4 a[144:147], v39, s[36:39], s97 offen offset:2048 sc1
    v_add_f32 v67, 1.0, v67
    v_add_f32 v68, 1.0, v68
    v_add_f32 v69, 1.0, v69
    v_mfma_f32_32x32x16_bf16 v[96:111], v[48:51], a[184:187], v[96:111]
    ds_read_b64_tr_b16 v[46:47], v13 offset:44032
    v_add_f32 v70, 1.0, v70
    v_add_f32 v71, 1.0, v71
    v_rcp_f32 v64, v64
    v_rcp_f32 v65, v65
    s_waitcnt lgkmcnt(4)
    v_mfma_f32_32x32x16_bf16 v[80:95], v[52:55], a[76:79], v[80:95]
    ds_read_b64_tr_b16 v[48:49], v13 offset:45056
    s_lshl_b32 s97, s51, 13
    s_add_u32 s97, s97, s96
    s_add_u32 s97, s97, 4096
    buffer_load_dwordx4 a[36:39], v38, s[36:39], s97 offen offset:2048 sc1
    v_rcp_f32 v66, v66
    v_mfma_f32_32x32x16_bf16 v[96:111], v[52:55], a[188:191], v[96:111]
    ds_read_b64_tr_b16 v[50:51], v13 offset:46080
    v_rcp_f32 v67, v67
    v_rcp_f32 v68, v68
    s_waitcnt lgkmcnt(4)
    v_mfma_f32_32x32x16_bf16 v[80:95], v[40:43], a[80:83], v[80:95]
    ds_read_b64_tr_b16 v[52:53], v13 offset:47104
    buffer_load_dwordx4 a[148:151], v39, s[36:39], s97 offen offset:2048 sc1
    v_rcp_f32 v69, v69
    v_rcp_f32 v70, v70
    v_mfma_f32_32x32x16_bf16 v[96:111], v[40:43], a[192:195], v[96:111]
    ds_read_b64_tr_b16 v[54:55], v13 offset:48128
    v_rcp_f32 v71, v71
    v_accvgpr_read_b32 v4, a248
    v_mul_f32 v64, v64, v4
    s_waitcnt lgkmcnt(4)
    v_mfma_f32_32x32x16_bf16 v[80:95], v[44:47], a[84:87], v[80:95]
    ds_read_b64_tr_b16 v[40:41], v13 offset:49152
    s_lshl_b32 s97, s52, 13
    s_add_u32 s97, s97, s96
    s_add_u32 s97, s97, 4096
    buffer_load_dwordx4 a[40:43], v38, s[36:39], s97 offen offset:2048 sc1
    v_accvgpr_read_b32 v5, a249
    v_mul_f32 v65, v65, v5
    v_mfma_f32_32x32x16_bf16 v[96:111], v[44:47], a[196:199], v[96:111]
    ds_read_b64_tr_b16 v[42:43], v13 offset:50176
    v_accvgpr_read_b32 v6, a250
    v_mul_f32 v66, v66, v6
    v_accvgpr_read_b32 v7, a251
    v_mul_f32 v67, v67, v7
    s_waitcnt lgkmcnt(4)
    v_mfma_f32_32x32x16_bf16 v[80:95], v[48:51], a[88:91], v[80:95]
    ds_read_b64_tr_b16 v[44:45], v13 offset:51200
    buffer_load_dwordx4 a[152:155], v39, s[36:39], s97 offen offset:2048 sc1
    v_accvgpr_read_b32 v4, a252
    v_mul_f32 v68, v68, v4
    v_accvgpr_read_b32 v5, a253
    v_mul_f32 v69, v69, v5
    v_mfma_f32_32x32x16_bf16 v[96:111], v[48:51], a[200:203], v[96:111]
    ds_read_b64_tr_b16 v[46:47], v13 offset:52224
    v_accvgpr_read_b32 v6, a254
    v_mul_f32 v70, v70, v6
    v_accvgpr_read_b32 v7, a255
    v_mul_f32 v71, v71, v7
    s_waitcnt lgkmcnt(4)
    v_mfma_f32_32x32x16_bf16 v[80:95], v[52:55], a[92:95], v[80:95]
    ds_read_b64_tr_b16 v[48:49], v13 offset:53248
    s_lshl_b32 s97, s53, 13
    s_add_u32 s97, s97, s96
    s_add_u32 s97, s97, 4096
    buffer_load_dwordx4 a[44:47], v38, s[36:39], s97 offen offset:2048 sc1
    v_cvt_pk_bf16_f32 v76, v64, v65
    v_mfma_f32_32x32x16_bf16 v[96:111], v[52:55], a[204:207], v[96:111]
    ds_read_b64_tr_b16 v[50:51], v13 offset:54272
    v_cvt_pk_bf16_f32 v77, v66, v67
    v_cvt_pk_bf16_f32 v78, v68, v69
    v_cvt_pk_bf16_f32 v79, v70, v71
    s_waitcnt lgkmcnt(4)
    v_mfma_f32_32x32x16_bf16 v[80:95], v[40:43], a[96:99], v[80:95]
    ds_read_b64_tr_b16 v[52:53], v13 offset:55296
    buffer_load_dwordx4 a[156:159], v39, s[36:39], s97 offen offset:2048 sc1
    buffer_store_dwordx4 v[72:75], v2, s[36:39], s87 offen offset:2048 sc1
    buffer_store_dwordx4 v[76:79], v2, s[36:39], s88 offen offset:2048 sc1
    v_mfma_f32_32x32x16_bf16 v[96:111], v[40:43], a[208:211], v[96:111]
    ds_read_b64_tr_b16 v[54:55], v13 offset:56320
    s_waitcnt lgkmcnt(4)
    v_mfma_f32_32x32x16_bf16 v[80:95], v[44:47], a[100:103], v[80:95]
    s_lshl_b32 s97, s54, 13
    s_add_u32 s97, s97, s96
    s_add_u32 s97, s97, 4096
    buffer_load_dwordx4 a[48:51], v38, s[36:39], s97 offen offset:2048 sc1
    v_mfma_f32_32x32x16_bf16 v[96:111], v[44:47], a[212:215], v[96:111]
    s_waitcnt lgkmcnt(2)
    v_mfma_f32_32x32x16_bf16 v[80:95], v[48:51], a[104:107], v[80:95]
    buffer_load_dwordx4 a[160:163], v39, s[36:39], s97 offen offset:2048 sc1
    s_load_dword s72, s[36:37], s73 glc
    v_mfma_f32_32x32x16_bf16 v[96:111], v[48:51], a[216:219], v[96:111]
    s_waitcnt lgkmcnt(0)
    v_mfma_f32_32x32x16_bf16 v[80:95], v[52:55], a[108:111], v[80:95]
    s_waitcnt vmcnt(2)
    s_add_u32 s74, s74, 4
    s_mov_b32 s45, 1
    s_atomic_add s45, s[36:37], s74
    v_mfma_f32_32x32x16_bf16 v[96:111], v[52:55], a[220:223], v[96:111]
    v_mov_b32 v32, v30
    v_mov_b32 v33, v31
    s_nop 1
    v_mfma_f32_32x32x16_bf16 v[80:95], v[32:35], v[16:19], v[80:95]
    v_mfma_f32_32x32x16_bf16 v[96:111], v[32:35], v[20:23], v[96:111]
    s_lshl_b32 s97, s55, 13
    s_add_u32 s97, s97, s96
    s_add_u32 s97, s97, 4096
    buffer_load_dwordx4 a[52:55], v38, s[36:39], s97 offen offset:2048 sc1
    buffer_load_dwordx4 a[164:167], v39, s[36:39], s97 offen offset:2048 sc1
    s_lshl_b32 s97, s56, 13
    s_add_u32 s97, s97, s96
    s_add_u32 s97, s97, 4096
    buffer_load_dwordx4 a[56:59], v38, s[36:39], s97 offen offset:2048 sc1
    buffer_load_dwordx4 a[168:171], v39, s[36:39], s97 offen offset:2048 sc1
    s_nop 0
    v_mul_f32 v56, v36, v80
    v_mul_f32 v57, v36, v81
    v_mul_f32 v58, v36, v82
    v_mul_f32 v59, v36, v83
    v_mul_f32 v60, v36, v84
    v_mul_f32 v61, v36, v85
    v_mul_f32 v62, v36, v86
    v_mul_f32 v63, v36, v87
    v_exp_f32 v56, v56
    v_exp_f32 v57, v57
    v_exp_f32 v58, v58
    v_exp_f32 v59, v59
    v_exp_f32 v60, v60
    v_exp_f32 v61, v61
    v_exp_f32 v62, v62
    v_exp_f32 v63, v63
    v_add_f32 v56, 1.0, v56
    v_add_f32 v57, 1.0, v57
    v_add_f32 v58, 1.0, v58
    v_add_f32 v59, 1.0, v59
    v_add_f32 v60, 1.0, v60
    v_add_f32 v61, 1.0, v61
    v_add_f32 v62, 1.0, v62
    v_add_f32 v63, 1.0, v63
    v_rcp_f32 v56, v56
    v_rcp_f32 v57, v57
    v_rcp_f32 v58, v58
    v_rcp_f32 v59, v59
    v_rcp_f32 v60, v60
    v_rcp_f32 v61, v61
    v_rcp_f32 v62, v62
    v_rcp_f32 v63, v63
    v_mul_f32 v56, v56, v88
    v_mul_f32 v57, v57, v89
    v_mul_f32 v58, v58, v90
    v_mul_f32 v59, v59, v91
    v_mul_f32 v60, v60, v92
    v_mul_f32 v61, v61, v93
    v_mul_f32 v62, v62, v94
    v_mul_f32 v63, v63, v95
    s_waitcnt lgkmcnt(0)
    s_cmp_lt_u32 s72, 7
    s_cbranch_scc1 Lp4late
    v_cvt_pk_bf16_f32 v72, v56, v57
    v_cvt_pk_bf16_f32 v73, v58, v59
    v_cvt_pk_bf16_f32 v74, v60, v61
    v_cvt_pk_bf16_f32 v75, v62, v63
    s_lshl_b32 s47, s50, 12
    s_add_u32 s46, s47, s89
    s_add_u32 s47, s47, s90
    buffer_load_dwordx4 a[228:231], v2, s[36:39], s47 offen offset:0 sc1
    v_mul_f32 v64, v37, v96
    v_mul_f32 v65, v37, v97
    v_mul_f32 v66, v37, v98
    buffer_load_dwordx4 a[224:227], v2, s[36:39], s46 offen offset:0 sc1
    v_mul_f32 v67, v37, v99
    v_mul_f32 v68, v37, v100
    v_mul_f32 v69, v37, v101
    s_lshl_b32 s47, s50, 12
    s_add_u32 s46, s47, s89
    s_add_u32 s47, s47, s90
    buffer_load_dwordx4 a[236:239], v2, s[36:39], s47 offen offset:1024 sc1
    v_mul_f32 v70, v37, v102
    v_mul_f32 v71, v37, v103
    v_exp_f32 v64, v64
    v_exp_f32 v65, v65
    buffer_load_dwordx4 a[232:235], v2, s[36:39], s46 offen offset:1024 sc1
    v_exp_f32 v66, v66
    v_exp_f32 v67, v67
    v_exp_f32 v68, v68
    s_lshl_b32 s47, s51, 12
    s_add_u32 s46, s47, s89
    s_add_u32 s47, s47, s90
    buffer_load_dwordx4 a[244:247], v2, s[36:39], s47 offen offset:0 sc1
    v_exp_f32 v69, v69
    v_exp_f32 v70, v70
    v_exp_f32 v71, v71
    buffer_load_dwordx4 a[240:243], v2, s[36:39], s46 offen offset:0 sc1
    v_add_f32 v64, 1.0, v64
    v_add_f32 v65, 1.0, v65
    v_add_f32 v66, 1.0, v66
    v_add_f32 v67, 1.0, v67
    s_lshl_b32 s47, s51, 12
    s_add_u32 s46, s47, s89
    s_add_u32 s47, s47, s90
    buffer_load_dwordx4 a[252:255], v2, s[36:39], s47 offen offset:1024 sc1
    v_add_f32 v68, 1.0, v68
    v_add_f32 v69, 1.0, v69
    v_add_f32 v70, 1.0, v70
    buffer_load_dwordx4 a[248:251], v2, s[36:39], s46 offen offset:1024 sc1
    v_add_f32 v71, 1.0, v71
    v_rcp_f32 v64, v64
    v_rcp_f32 v65, v65
    s_lshl_b32 s47, s52, 12
    s_add_u32 s46, s47, s89
    s_add_u32 s47, s47, s90
    buffer_load_dwordx4 a[172:175], v2, s[36:39], s47 offen offset:0 sc1
    v_rcp_f32 v66, v66
    v_rcp_f32 v67, v67
    v_rcp_f32 v68, v68
    buffer_load_dwordx4 a[60:63], v2, s[36:39], s46 offen offset:0 sc1
    v_rcp_f32 v69, v69
    v_rcp_f32 v70, v70
    v_rcp_f32 v71, v71
    v_mul_f32 v64, v64, v104
    v_mul_f32 v65, v65, v105
    v_mul_f32 v66, v66, v106
    v_mul_f32 v67, v67, v107
    v_mul_f32 v68, v68, v108
    v_mul_f32 v69, v69, v109
    v_mul_f32 v70, v70, v110
    v_mul_f32 v71, v71, v111
    v_cvt_pk_bf16_f32 v76, v64, v65
    v_cvt_pk_bf16_f32 v77, v66, v67
    v_cvt_pk_bf16_f32 v78, v68, v69
    v_cvt_pk_bf16_f32 v79, v70, v71
    buffer_store_dwordx4 v[72:75], v2, s[36:39], s87 offen offset:3072 sc1
    buffer_store_dwordx4 v[76:79], v2, s[36:39], s88 offen offset:3072 sc1
    s_branch Lp4go
Lp4late:
    v_cvt_pk_bf16_f32 v72, v56, v57
    v_cvt_pk_bf16_f32 v73, v58, v59
    v_cvt_pk_bf16_f32 v74, v60, v61
    v_cvt_pk_bf16_f32 v75, v62, v63
    v_mul_f32 v64, v37, v96
    v_mul_f32 v65, v37, v97
    v_mul_f32 v66, v37, v98
    v_mul_f32 v67, v37, v99
    v_mul_f32 v68, v37, v100
    v_mul_f32 v69, v37, v101
    v_mul_f32 v70, v37, v102
    v_mul_f32 v71, v37, v103
    v_exp_f32 v64, v64
    v_exp_f32 v65, v65
    v_exp_f32 v66, v66
    v_exp_f32 v67, v67
    v_exp_f32 v68, v68
    v_exp_f32 v69, v69
    v_exp_f32 v70, v70
    v_exp_f32 v71, v71
    v_add_f32 v64, 1.0, v64
    v_add_f32 v65, 1.0, v65
    v_add_f32 v66, 1.0, v66
    v_add_f32 v67, 1.0, v67
    v_add_f32 v68, 1.0, v68
    v_add_f32 v69, 1.0, v69
    v_add_f32 v70, 1.0, v70
    v_add_f32 v71, 1.0, v71
    v_rcp_f32 v64, v64
    v_rcp_f32 v65, v65
    v_rcp_f32 v66, v66
    v_rcp_f32 v67, v67
    v_rcp_f32 v68, v68
    v_rcp_f32 v69, v69
    v_rcp_f32 v70, v70
    v_rcp_f32 v71, v71
    v_mul_f32 v64, v64, v104
    v_mul_f32 v65, v65, v105
    v_mul_f32 v66, v66, v106
    v_mul_f32 v67, v67, v107
    v_mul_f32 v68, v68, v108
    v_mul_f32 v69, v69, v109
    v_mul_f32 v70, v70, v110
    v_mul_f32 v71, v71, v111
    v_cvt_pk_bf16_f32 v76, v64, v65
    v_cvt_pk_bf16_f32 v77, v66, v67
    v_cvt_pk_bf16_f32 v78, v68, v69
    v_cvt_pk_bf16_f32 v79, v70, v71
    buffer_store_dwordx4 v[72:75], v2, s[36:39], s87 offen offset:3072 sc1
    buffer_store_dwordx4 v[76:79], v2, s[36:39], s88 offen offset:3072 sc1
    s_mov_b32 s59, 0
Lspin18:
    s_load_dword s72, s[36:37], s73 glc
    s_waitcnt lgkmcnt(0)
    s_cmp_lt_u32 s72, 7
    s_cbranch_scc1 Lretry20
    s_branch Lout19
Lretry20:
    s_sleep 1
    s_add_u32 s59, s59, 1
    s_cmp_lt_u32 s59, 200000
    s_cbranch_scc1 Lspin18
Lout19:
    s_lshl_b32 s47, s50, 12
    s_add_u32 s46, s47, s89
    s_add_u32 s47, s47, s90
    buffer_load_dwordx4 a[228:231], v2, s[36:39], s47 offen offset:0 sc1
    buffer_load_dwordx4 a[224:227], v2, s[36:39], s46 offen offset:0 sc1
    s_lshl_b32 s47, s50, 12
    s_add_u32 s46, s47, s89
    s_add_u32 s47, s47, s90
    buffer_load_dwordx4 a[236:239], v2, s[36:39], s47 offen offset:1024 sc1
    buffer_load_dwordx4 a[232:235], v2, s[36:39], s46 offen offset:1024 sc1
    s_lshl_b32 s47, s51, 12
    s_add_u32 s46, s47, s89
    s_add_u32 s47, s47, s90
    buffer_load_dwordx4 a[244:247], v2, s[36:39], s47 offen offset:0 sc1
    buffer_load_dwordx4 a[240:243], v2, s[36:39], s46 offen offset:0 sc1
    s_lshl_b32 s47, s51, 12
    s_add_u32 s46, s47, s89
    s_add_u32 s47, s47, s90
    buffer_load_dwordx4 a[252:255], v2, s[36:39], s47 offen offset:1024 sc1
    buffer_load_dwordx4 a[248:251], v2, s[36:39], s46 offen offset:1024 sc1
    s_lshl_b32 s47, s52, 12
    s_add_u32 s46, s47, s89
    s_add_u32 s47, s47, s90
    buffer_load_dwordx4 a[172:175], v2, s[36:39], s47 offen offset:0 sc1
    buffer_load_dwordx4 a[60:63], v2, s[36:39], s46 offen offset:0 sc1
    buffer_load_dword v1, v2, s[36:39], s89 offen sc1
    buffer_load_dword v1, v2, s[36:39], s89 offen sc1
Lp4go:
    s_waitcnt vmcnt(11)
    v_mfma_f32_32x32x16_bf16 v[112:127], v[152:155], a[228:231], 0
    v_mfma_f32_32x32x16_bf16 v[128:143], v[156:159], a[228:231], 0
    s_lshl_b32 s47, s52, 12
    s_add_u32 s47, s47, s90
    buffer_load_dwordx4 a[176:179], v2, s[36:39], s47 offen offset:1024 sc1
    s_waitcnt vmcnt(11)
    v_mfma_f32_32x32x16_bf16 v[80:95], v[152:155], a[224:227], 0
    v_mfma_f32_32x32x16_bf16 v[96:111], v[156:159], a[224:227], 0
    s_lshl_b32 s47, s52, 12
    s_add_u32 s47, s47, s89
    buffer_load_dwordx4 a[64:67], v2, s[36:39], s47 offen offset:1024 sc1
    s_waitcnt vmcnt(11)
    v_mfma_f32_32x32x16_bf16 v[112:127], v[160:163], a[236:239], v[112:127]
    v_mfma_f32_32x32x16_bf16 v[128:143], v[164:167], a[236:239], v[128:143]
    s_lshl_b32 s47, s53, 12
    s_add_u32 s47, s47, s90
    buffer_load_dwordx4 a[180:183], v2, s[36:39], s47 offen offset:0 sc1
    s_waitcnt vmcnt(11)
    v_mfma_f32_32x32x16_bf16 v[80:95], v[160:163], a[232:235], v[80:95]
    v_mfma_f32_32x32x16_bf16 v[96:111], v[164:167], a[232:235], v[96:111]
    s_lshl_b32 s47, s53, 12
    s_add_u32 s47, s47, s89
    buffer_load_dwordx4 a[68:71], v2, s[36:39], s47 offen offset:0 sc1
    s_waitcnt vmcnt(11)
    v_mfma_f32_32x32x16_bf16 v[112:127], v[168:171], a[244:247], v[112:127]
    v_mfma_f32_32x32x16_bf16 v[128:143], v[172:175], a[244:247], v[128:143]
    s_lshl_b32 s47, s53, 12
    s_add_u32 s47, s47, s90
    buffer_load_dwordx4 a[184:187], v2, s[36:39], s47 offen offset:1024 sc1
    s_waitcnt vmcnt(11)
    v_mfma_f32_32x32x16_bf16 v[80:95], v[168:171], a[240:243], v[80:95]
    v_mfma_f32_32x32x16_bf16 v[96:111], v[172:175], a[240:243], v[96:111]
    s_lshl_b32 s47, s53, 12
    s_add_u32 s47, s47, s89
    buffer_load_dwordx4 a[72:75], v2, s[36:39], s47 offen offset:1024 sc1
    s_waitcnt vmcnt(11)
    v_mfma_f32_32x32x16_bf16 v[112:127], v[176:179], a[252:255], v[112:127]
    v_mfma_f32_32x32x16_bf16 v[128:143], v[180:183], a[252:255], v[128:143]
    s_lshl_b32 s47, s54, 12
    s_add_u32 s47, s47, s90
    buffer_load_dwordx4 a[228:231], v2, s[36:39], s47 offen offset:0 sc1
    s_waitcnt vmcnt(11)
    v_mfma_f32_32x32x16_bf16 v[80:95], v[176:179], a[248:251], v[80:95]
    v_mfma_f32_32x32x16_bf16 v[96:111], v[180:183], a[248:251], v[96:111]
    s_lshl_b32 s47, s54, 12
    s_add_u32 s47, s47, s89
    buffer_load_dwordx4 a[224:227], v2, s[36:39], s47 offen offset:0 sc1
    s_waitcnt vmcnt(11)
    v_mfma_f32_32x32x16_bf16 v[112:127], v[184:187], a[172:175], v[112:127]
    s_waitcnt vmcnt(8)
    s_add_u32 s74, s74, 4
    s_mov_b32 s45, 1
    s_atomic_add s45, s[36:37], s74
    v_mfma_f32_32x32x16_bf16 v[128:143], v[188:191], a[172:175], v[128:143]
    s_lshl_b32 s47, s54, 12
    s_add_u32 s47, s47, s90
    buffer_load_dwordx4 a[236:239], v2, s[36:39], s47 offen offset:1024 sc1
    v_mfma_f32_32x32x16_bf16 v[80:95], v[184:187], a[60:63], v[80:95]
    v_mfma_f32_32x32x16_bf16 v[96:111], v[188:191], a[60:63], v[96:111]
    s_lshl_b32 s47, s54, 12
    s_add_u32 s47, s47, s89
    buffer_load_dwordx4 a[232:235], v2, s[36:39], s47 offen offset:1024 sc1
    s_waitcnt vmcnt(9)
    v_mfma_f32_32x32x16_bf16 v[112:127], v[192:195], a[176:179], v[112:127]
    s_add_u32 s73, s73, 4
    s_load_dword s72, s[36:37], s73 glc
    v_mfma_f32_32x32x16_bf16 v[128:143], v[196:199], a[176:179], v[128:143]
    s_lshl_b32 s47, s55, 12
    s_add_u32 s47, s47, s90
    buffer_load_dwordx4 a[244:247], v2, s[36:39], s47 offen offset:0 sc1
    s_waitcnt vmcnt(9)
    v_mfma_f32_32x32x16_bf16 v[80:95], v[192:195], a[64:67], v[80:95]
    v_mfma_f32_32x32x16_bf16 v[96:111], v[196:199], a[64:67], v[96:111]
    s_lshl_b32 s47, s55, 12
    s_add_u32 s47, s47, s89
    buffer_load_dwordx4 a[240:243], v2, s[36:39], s47 offen offset:0 sc1
    s_waitcnt vmcnt(9)
    v_mfma_f32_32x32x16_bf16 v[112:127], v[200:203], a[180:183], v[112:127]
    v_mfma_f32_32x32x16_bf16 v[128:143], v[204:207], a[180:183], v[128:143]
    s_lshl_b32 s47, s55, 12
    s_add_u32 s47, s47, s90
    buffer_load_dwordx4 a[252:255], v2, s[36:39], s47 offen offset:1024 sc1
    s_waitcnt vmcnt(9)
    v_mfma_f32_32x32x16_bf16 v[80:95], v[200:203], a[68:71], v[80:95]
    v_mfma_f32_32x32x16_bf16 v[96:111], v[204:207], a[68:71], v[96:111]
    s_lshl_b32 s47, s55, 12
    s_add_u32 s47, s47, s89
    buffer_load_dwordx4 a[248:251], v2, s[36:39], s47 offen offset:1024 sc1
    s_waitcnt vmcnt(9)
    v_mfma_f32_32x32x16_bf16 v[112:127], v[208:211], a[184:187], v[112:127]
    v_mfma_f32_32x32x16_bf16 v[128:143], v[212:215], a[184:187], v[128:143]
    s_lshl_b32 s47, s56, 12
    s_add_u32 s47, s47, s90
    buffer_load_dwordx4 a[172:175], v2, s[36:39], s47 offen offset:0 sc1
    s_waitcnt vmcnt(9)
    v_mfma_f32_32x32x16_bf16 v[80:95], v[208:211], a[72:75], v[80:95]
    v_mfma_f32_32x32x16_bf16 v[96:111], v[212:215], a[72:75], v[96:111]
    s_lshl_b32 s47, s56, 12
    s_add_u32 s47, s47, s89
    buffer_load_dwordx4 a[60:63], v2, s[36:39], s47 offen offset:0 sc1
    s_waitcnt vmcnt(9)
    v_mfma_f32_32x32x16_bf16 v[112:127], v[216:219], a[228:231], v[112:127]
    s_waitcnt lgkmcnt(0)
    s_cmp_lt_u32 s72, 7
    s_cbranch_scc1 Lsc21_slow
Lsc21:
    v_mfma_f32_32x32x16_bf16 v[128:143], v[220:223], a[228:231], v[128:143]
    s_lshl_b32 s47, s56, 12
    s_add_u32 s47, s47, s90
    buffer_load_dwordx4 a[176:179], v2, s[36:39], s47 offen offset:1024 sc1
    s_waitcnt vmcnt(9)
    v_mfma_f32_32x32x16_bf16 v[80:95], v[216:219], a[224:227], v[80:95]
    v_mfma_f32_32x32x16_bf16 v[96:111], v[220:223], a[224:227], v[96:111]
    s_lshl_b32 s47, s56, 12
    s_add_u32 s47, s47, s89
    buffer_load_dwordx4 a[64:67], v2, s[36:39], s47 offen offset:1024 sc1
    s_waitcnt vmcnt(9)
    v_mfma_f32_32x32x16_bf16 v[112:127], v[224:227], a[236:239], v[112:127]
    v_mfma_f32_32x32x16_bf16 v[128:143], v[228:231], a[236:239], v[128:143]
    s_lshl_b32 s47, s50, 12
    s_add_u32 s47, s47, s90
    buffer_load_dwordx4 a[180:183], v2, s[36:39], s47 offen offset:2048 sc1
    s_waitcnt vmcnt(9)
    v_mfma_f32_32x32x16_bf16 v[80:95], v[224:227], a[232:235], v[80:95]
    v_mfma_f32_32x32x16_bf16 v[96:111], v[228:231], a[232:235], v[96:111]
    s_lshl_b32 s47, s50, 12
    s_add_u32 s47, s47, s89
    buffer_load_dwordx4 a[68:71], v2, s[36:39], s47 offen offset:2048 sc1
    s_waitcnt vmcnt(9)
    v_mfma_f32_32x32x16_bf16 v[112:127], v[232:235], a[244:247], v[112:127]
    v_mfma_f32_32x32x16_bf16 v[128:143], v[236:239], a[244:247], v[128:143]
    s_lshl_b32 s47, s51, 12
    s_add_u32 s47, s47, s90
    buffer_load_dwordx4 a[184:187], v2, s[36:39], s47 offen offset:2048 sc1
    s_waitcnt vmcnt(9)
    v_mfma_f32_32x32x16_bf16 v[80:95], v[232:235], a[240:243], v[80:95]
    v_mfma_f32_32x32x16_bf16 v[96:111], v[236:239], a[240:243], v[96:111]
    s_lshl_b32 s47, s51, 12
    s_add_u32 s47, s47, s89
    buffer_load_dwordx4 a[72:75], v2, s[36:39], s47 offen offset:2048 sc1
    s_waitcnt vmcnt(9)
    v_mfma_f32_32x32x16_bf16 v[112:127], v[240:243], a[252:255], v[112:127]
    v_mfma_f32_32x32x16_bf16 v[128:143], v[244:247], a[252:255], v[128:143]
    s_lshl_b32 s47, s52, 12
    s_add_u32 s47, s47, s90
    buffer_load_dwordx4 a[228:231], v2, s[36:39], s47 offen offset:2048 sc1
    s_waitcnt vmcnt(9)
    v_mfma_f32_32x32x16_bf16 v[80:95], v[240:243], a[248:251], v[80:95]
    v_mfma_f32_32x32x16_bf16 v[96:111], v[244:247], a[248:251], v[96:111]
    s_lshl_b32 s47, s52, 12
    s_add_u32 s47, s47, s89
    buffer_load_dwordx4 a[224:227], v2, s[36:39], s47 offen offset:2048 sc1
    s_waitcnt vmcnt(9)
    v_mfma_f32_32x32x16_bf16 v[112:127], v[248:251], a[172:175], v[112:127]
    s_add_u32 s73, s73, 4
    s_load_dword s72, s[36:37], s73 glc
    v_mfma_f32_32x32x16_bf16 v[128:143], v[252:255], a[172:175], v[128:143]
    s_lshl_b32 s47, s53, 12
    s_add_u32 s47, s47, s90
    buffer_load_dwordx4 a[236:239], v2, s[36:39], s47 offen offset:2048 sc1
    s_waitcnt vmcnt(9)
    v_mfma_f32_32x32x16_bf16 v[80:95], v[248:251], a[60:63], v[80:95]
    v_mfma_f32_32x32x16_bf16 v[96:111], v[252:255], a[60:63], v[96:111]
    s_lshl_b32 s47, s53, 12
    s_add_u32 s47, s47, s89
    buffer_load_dwordx4 a[232:235], v2, s[36:39], s47 offen offset:2048 sc1
    s_waitcnt vmcnt(9)
    v_mfma_f32_32x32x16_bf16 v[112:127], a[0:3], a[176:179], v[112:127]
    v_mfma_f32_32x32x16_bf16 v[128:143], a[112:115], a[176:179], v[128:143]
    s_lshl_b32 s47, s54, 12
    s_add_u32 s47, s47, s90
    buffer_load_dwordx4 a[244:247], v2, s[36:39], s47 offen offset:2048 sc1
    s_waitcnt vmcnt(9)
    v_mfma_f32_32x32x16_bf16 v[80:95], a[0:3], a[64:67], v[80:95]
    v_mfma_f32_32x32x16_bf16 v[96:111], a[112:115], a[64:67], v[96:111]
    s_lshl_b32 s47, s54, 12
    s_add_u32 s47, s47, s89
    buffer_load_dwordx4 a[240:243], v2, s[36:39], s47 offen offset:2048 sc1
    s_waitcnt vmcnt(9)
    v_mfma_f32_32x32x16_bf16 v[112:127], a[4:7], a[180:183], v[112:127]
    v_mfma_f32_32x32x16_bf16 v[128:143], a[116:119], a[180:183], v[128:143]
    s_lshl_b32 s47, s55, 12
    s_add_u32 s47, s47, s90
    buffer_load_dwordx4 a[252:255], v2, s[36:39], s47 offen offset:2048 sc1
    s_waitcnt vmcnt(9)
    v_mfma_f32_32x32x16_bf16 v[80:95], a[4:7], a[68:71], v[80:95]
    v_mfma_f32_32x32x16_bf16 v[96:111], a[116:119], a[68:71], v[96:111]
    s_lshl_b32 s47, s55, 12
    s_add_u32 s47, s47, s89
    buffer_load_dwordx4 a[248:251], v2, s[36:39], s47 offen offset:2048 sc1
    s_waitcnt vmcnt(9)
    v_mfma_f32_32x32x16_bf16 v[112:127], a[8:11], a[184:187], v[112:127]
    s_waitcnt lgkmcnt(0)
    s_cmp_lt_u32 s72, 7
    s_cbranch_scc1 Lsc22_slow
Lsc22:
    v_mfma_f32_32x32x16_bf16 v[128:143], a[120:123], a[184:187], v[128:143]
    s_lshl_b32 s47, s56, 12
    s_add_u32 s47, s47, s90
    buffer_load_dwordx4 a[172:175], v2, s[36:39], s47 offen offset:2048 sc1
    s_waitcnt vmcnt(9)
    v_mfma_f32_32x32x16_bf16 v[80:95], a[8:11], a[72:75], v[80:95]
    v_mfma_f32_32x32x16_bf16 v[96:111], a[120:123], a[72:75], v[96:111]
    s_lshl_b32 s47, s56, 12
    s_add_u32 s47, s47, s89
    buffer_load_dwordx4 a[60:63], v2, s[36:39], s47 offen offset:2048 sc1
    s_waitcnt vmcnt(9)
    v_mfma_f32_32x32x16_bf16 v[112:127], a[12:15], a[228:231], v[112:127]
    v_mfma_f32_32x32x16_bf16 v[128:143], a[124:127], a[228:231], v[128:143]
    s_lshl_b32 s47, s50, 12
    s_add_u32 s47, s47, s90
    buffer_load_dwordx4 v[156:159], v2, s[36:39], s47 offen offset:3072 sc1
    s_waitcnt vmcnt(9)
    v_mfma_f32_32x32x16_bf16 v[80:95], a[12:15], a[224:227], v[80:95]
    v_mfma_f32_32x32x16_bf16 v[96:111], a[124:127], a[224:227], v[96:111]
    s_lshl_b32 s47, s51, 12
    s_add_u32 s47, s47, s90
    buffer_load_dwordx4 v[164:167], v2, s[36:39], s47 offen offset:3072 sc1
    s_waitcnt vmcnt(9)
    v_mfma_f32_32x32x16_bf16 v[112:127], a[16:19], a[236:239], v[112:127]
    v_mfma_f32_32x32x16_bf16 v[128:143], a[128:131], a[236:239], v[128:143]
    s_lshl_b32 s47, s52, 12
    s_add_u32 s47, s47, s90
    buffer_load_dwordx4 v[172:175], v2, s[36:39], s47 offen offset:3072 sc1
    s_waitcnt vmcnt(9)
    v_mfma_f32_32x32x16_bf16 v[80:95], a[16:19], a[232:235], v[80:95]
    v_mfma_f32_32x32x16_bf16 v[96:111], a[128:131], a[232:235], v[96:111]
    s_lshl_b32 s47, s53, 12
    s_add_u32 s47, s47, s90
    buffer_load_dwordx4 v[180:183], v2, s[36:39], s47 offen offset:3072 sc1
    s_waitcnt vmcnt(9)
    v_mfma_f32_32x32x16_bf16 v[112:127], a[20:23], a[244:247], v[112:127]
    v_mfma_f32_32x32x16_bf16 v[128:143], a[132:135], a[244:247], v[128:143]
    s_lshl_b32 s47, s54, 12
    s_add_u32 s47, s47, s90
    buffer_load_dwordx4 v[188:191], v2, s[36:39], s47 offen offset:3072 sc1
    s_waitcnt vmcnt(9)
    v_mfma_f32_32x32x16_bf16 v[80:95], a[20:23], a[240:243], v[80:95]
    v_mfma_f32_32x32x16_bf16 v[96:111], a[132:135], a[240:243], v[96:111]
    s_lshl_b32 s47, s55, 12
    s_add_u32 s47, s47, s90
    buffer_load_dwordx4 v[196:199], v2, s[36:39], s47 offen offset:3072 sc1
    s_waitcnt vmcnt(9)
    v_mfma_f32_32x32x16_bf16 v[112:127], a[24:27], a[252:255], v[112:127]
    v_mfma_f32_32x32x16_bf16 v[128:143], a[136:139], a[252:255], v[128:143]
    s_lshl_b32 s47, s56, 12
    s_add_u32 s47, s47, s90
    buffer_load_dwordx4 v[204:207], v2, s[36:39], s47 offen offset:3072 sc1
    s_waitcnt vmcnt(9)
    v_mfma_f32_32x32x16_bf16 v[80:95], a[24:27], a[248:251], v[80:95]
    v_mfma_f32_32x32x16_bf16 v[96:111], a[136:139], a[248:251], v[96:111]
    s_lshl_b32 s47, s50, 12
    s_add_u32 s47, s47, s89
    buffer_load_dwordx4 v[152:155], v2, s[36:39], s47 offen offset:3072 sc1
    s_waitcnt vmcnt(9)
    v_mfma_f32_32x32x16_bf16 v[112:127], a[28:31], a[172:175], v[112:127]
    v_mfma_f32_32x32x16_bf16 v[128:143], a[140:143], a[172:175], v[128:143]
    s_lshl_b32 s47, s51, 12
    s_add_u32 s47, s47, s89
    buffer_load_dwordx4 v[160:163], v2, s[36:39], s47 offen offset:3072 sc1
    s_waitcnt vmcnt(9)
    v_mfma_f32_32x32x16_bf16 v[80:95], a[28:31], a[60:63], v[80:95]
    v_mfma_f32_32x32x16_bf16 v[96:111], a[140:143], a[60:63], v[96:111]
    s_lshl_b32 s47, s52, 12
    s_add_u32 s47, s47, s89
    buffer_load_dwordx4 v[168:171], v2, s[36:39], s47 offen offset:3072 sc1
    s_waitcnt vmcnt(9)
    v_mfma_f32_32x32x16_bf16 v[112:127], a[32:35], v[156:159], v[112:127]
    v_mfma_f32_32x32x16_bf16 v[128:143], a[144:147], v[156:159], v[128:143]
    s_lshl_b32 s47, s53, 12
    s_add_u32 s47, s47, s89
    buffer_load_dwordx4 v[176:179], v2, s[36:39], s47 offen offset:3072 sc1
    s_waitcnt vmcnt(9)
    v_mfma_f32_32x32x16_bf16 v[112:127], a[36:39], v[164:167], v[112:127]
    v_mfma_f32_32x32x16_bf16 v[128:143], a[148:151], v[164:167], v[128:143]
    s_lshl_b32 s47, s54, 12
    s_add_u32 s47, s47, s89
    buffer_load_dwordx4 v[184:187], v2, s[36:39], s47 offen offset:3072 sc1
    s_waitcnt vmcnt(9)
    v_mfma_f32_32x32x16_bf16 v[112:127], a[40:43], v[172:175], v[112:127]
    v_mfma_f32_32x32x16_bf16 v[128:143], a[152:155], v[172:175], v[128:143]
    s_lshl_b32 s47, s55, 12
    s_add_u32 s47, s47, s89
    buffer_load_dwordx4 v[192:195], v2, s[36:39], s47 offen offset:3072 sc1
    s_xor_b32 s49, s42, 1
    s_mul_i32 s49, s49, 12288
    s_add_u32 s49, s49, 0
    v_add_u32 v64, s49, v2
    s_xor_b32 s49, s42, 2
    s_mul_i32 s49, s49, 12288
    s_add_u32 s49, s49, 4096
    v_add_u32 v65, s49, v2
    s_xor_b32 s49, s42, 3
    s_mul_i32 s49, s49, 12288
    s_add_u32 s49, s49, 8192
    v_add_u32 v66, s49, v2
    s_mul_i32 s49, s42, 12288
    v_add_u32 v67, s49, v2
    s_waitcnt vmcnt(9)
    v_mfma_f32_32x32x16_bf16 v[112:127], a[44:47], v[180:183], v[112:127]
    v_mfma_f32_32x32x16_bf16 v[128:143], a[156:159], v[180:183], v[128:143]
    s_lshl_b32 s47, s56, 12
    s_add_u32 s47, s47, s89
    buffer_load_dwordx4 v[200:203], v2, s[36:39], s47 offen offset:3072 sc1
    s_waitcnt vmcnt(9)
    v_mfma_f32_32x32x16_bf16 v[112:127], a[48:51], v[188:191], v[112:127]
    v_mfma_f32_32x32x16_bf16 v[128:143], a[160:163], v[188:191], v[128:143]
    v_and_b32 v4, 31, v0
    v_mul_u32_u24 v4, 896, v4
    v_lshrrev_b32 v5, 5, v0
    v_lshl_add_u32 v10, v5, 4, v4
    s_mul_i32 s87, s58, 28672
    s_lshl_b32 s88, s44, 7
    s_add_u32 s87, s87, s88
    s_lshl_b32 s88, s76, 6
    s_add_u32 s87, s87, s88
    s_waitcnt vmcnt(8)
    v_mfma_f32_32x32x16_bf16 v[112:127], a[52:55], v[196:199], v[112:127]
    v_mfma_f32_32x32x16_bf16 v[128:143], a[164:167], v[196:199], v[128:143]
    s_waitcnt vmcnt(7)
    v_mfma_f32_32x32x16_bf16 v[112:127], a[56:59], v[204:207], v[112:127]
    v_mfma_f32_32x32x16_bf16 v[128:143], a[168:171], v[204:207], v[128:143]
    s_waitcnt vmcnt(6)
    v_mfma_f32_32x32x16_bf16 v[80:95], a[32:35], v[152:155], v[80:95]
    v_mfma_f32_32x32x16_bf16 v[96:111], a[144:147], v[152:155], v[96:111]
    s_waitcnt vmcnt(5)
    v_mfma_f32_32x32x16_bf16 v[80:95], a[36:39], v[160:163], v[80:95]
    s_nop 5
    ds_write_b128 v65, v[112:115] offset:0
    ds_write_b128 v65, v[116:119] offset:1024
    v_mfma_f32_32x32x16_bf16 v[96:111], a[148:151], v[160:163], v[96:111]
    s_waitcnt vmcnt(4)
    v_mfma_f32_32x32x16_bf16 v[80:95], a[40:43], v[168:171], v[80:95]
    ds_write_b128 v65, v[120:123] offset:2048
    ds_write_b128 v65, v[124:127] offset:3072
    v_mfma_f32_32x32x16_bf16 v[96:111], a[152:155], v[168:171], v[96:111]
    s_waitcnt vmcnt(3)
    v_mfma_f32_32x32x16_bf16 v[80:95], a[44:47], v[176:179], v[80:95]
    ds_write_b128 v66, v[128:131] offset:0
    ds_write_b128 v66, v[132:135] offset:1024
    v_mfma_f32_32x32x16_bf16 v[96:111], a[156:159], v[176:179], v[96:111]
    s_waitcnt vmcnt(2)
    v_mfma_f32_32x32x16_bf16 v[80:95], a[48:51], v[184:187], v[80:95]
    ds_write_b128 v66, v[136:139] offset:2048
    ds_write_b128 v66, v[140:143] offset:3072
    v_mfma_f32_32x32x16_bf16 v[96:111], a[160:163], v[184:187], v[96:111]
    s_waitcnt vmcnt(1)
    v_mfma_f32_32x32x16_bf16 v[96:111], a[164:167], v[192:195], v[96:111]
    s_waitcnt vmcnt(0)
    v_mfma_f32_32x32x16_bf16 v[96:111], a[168:171], v[200:203], v[96:111]
    v_mfma_f32_32x32x16_bf16 v[80:95], a[52:55], v[192:195], v[80:95]
    s_nop 10
    ds_write_b128 v64, v[96:99] offset:0
    ds_write_b128 v64, v[100:103] offset:1024
    ds_write_b128 v64, v[104:107] offset:2048
    ds_write_b128 v64, v[108:111] offset:3072
    v_mfma_f32_32x32x16_bf16 v[80:95], a[56:59], v[200:203], v[80:95]
    s_waitcnt lgkmcnt(0)
    s_barrier
    ds_read_b128 v[16:19], v67 offset:0
    ds_read_b128 v[20:23], v67 offset:1024
    ds_read_b128 v[24:27], v67 offset:2048
    ds_read_b128 v[28:31], v67 offset:3072
    ds_read_b128 v[32:35], v67 offset:4096
    ds_read_b128 v[36:39], v67 offset:5120
    ds_read_b128 v[40:43], v67 offset:6144
    ds_read_b128 v[44:47], v67 offset:7168
    ds_read_b128 v[48:51], v67 offset:8192
    ds_read_b128 v[52:55], v67 offset:9216
    ds_read_b128 v[56:59], v67 offset:10240
    ds_read_b128 v[60:63], v67 offset:11264
    s_waitcnt lgkmcnt(11)
    v_pk_add_f32 v[80:81], v[80:81], v[16:17]
    v_pk_add_f32 v[82:83], v[82:83], v[18:19]
    s_waitcnt lgkmcnt(10)
    v_pk_add_f32 v[84:85], v[84:85], v[20:21]
    v_pk_add_f32 v[86:87], v[86:87], v[22:23]
    s_waitcnt lgkmcnt(9)
    v_pk_add_f32 v[88:89], v[88:89], v[24:25]
    v_pk_add_f32 v[90:91], v[90:91], v[26:27]
    s_waitcnt lgkmcnt(8)
    v_pk_add_f32 v[92:93], v[92:93], v[28:29]
    v_pk_add_f32 v[94:95], v[94:95], v[30:31]
    s_waitcnt lgkmcnt(7)
    v_pk_add_f32 v[80:81], v[80:81], v[32:33]
    v_pk_add_f32 v[82:83], v[82:83], v[34:35]
    s_waitcnt lgkmcnt(6)
    v_pk_add_f32 v[84:85], v[84:85], v[36:37]
    v_pk_add_f32 v[86:87], v[86:87], v[38:39]
    s_waitcnt lgkmcnt(5)
    v_pk_add_f32 v[88:89], v[88:89], v[40:41]
    v_pk_add_f32 v[90:91], v[90:91], v[42:43]
    s_waitcnt lgkmcnt(4)
    v_pk_add_f32 v[92:93], v[92:93], v[44:45]
    v_pk_add_f32 v[94:95], v[94:95], v[46:47]
    s_waitcnt lgkmcnt(3)
    v_pk_add_f32 v[80:81], v[80:81], v[48:49]
    v_pk_add_f32 v[82:83], v[82:83], v[50:51]
    s_waitcnt lgkmcnt(2)
    v_pk_add_f32 v[84:85], v[84:85], v[52:53]
    v_pk_add_f32 v[86:87], v[86:87], v[54:55]
    s_waitcnt lgkmcnt(1)
    v_pk_add_f32 v[88:89], v[88:89], v[56:57]
    v_pk_add_f32 v[90:91], v[90:91], v[58:59]
    s_waitcnt lgkmcnt(0)
    v_pk_add_f32 v[92:93], v[92:93], v[60:61]
    v_pk_add_f32 v[94:95], v[94:95], v[62:63]
    v_pk_mul_f32 v[80:81], v[80:81], v[8:9] op_sel:[0,1]
    v_pk_mul_f32 v[82:83], v[82:83], v[8:9] op_sel:[0,1]
    v_pk_mul_f32 v[84:85], v[84:85], v[8:9] op_sel:[0,1]
    v_pk_mul_f32 v[86:87], v[86:87], v[8:9] op_sel:[0,1]
    v_pk_mul_f32 v[88:89], v[88:89], v[8:9] op_sel:[0,1]
    v_pk_mul_f32 v[90:91], v[90:91], v[8:9] op_sel:[0,1]
    v_pk_mul_f32 v[92:93], v[92:93], v[8:9] op_sel:[0,1]
    v_pk_mul_f32 v[94:95], v[94:95], v[8:9] op_sel:[0,1]
    v_dot2_f32_bf16 v80, v144, s91, v80
    v_dot2_f32_bf16 v81, v144, s92, v81
    v_dot2_f32_bf16 v82, v145, s91, v82
    v_dot2_f32_bf16 v83, v145, s92, v83
    v_dot2_f32_bf16 v84, v146, s91, v84
    v_dot2_f32_bf16 v85, v146, s92, v85
    v_dot2_f32_bf16 v86, v147, s91, v86
    v_dot2_f32_bf16 v87, v147, s92, v87
    v_dot2_f32_bf16 v88, v148, s91, v88
    v_dot2_f32_bf16 v89, v148, s92, v89
    v_dot2_f32_bf16 v90, v149, s91, v90
    v_dot2_f32_bf16 v91, v149, s92, v91
    v_dot2_f32_bf16 v92, v150, s91, v92
    v_dot2_f32_bf16 v93, v150, s92, v93
    v_dot2_f32_bf16 v94, v151, s91, v94
    v_dot2_f32_bf16 v95, v151, s92, v95
    v_cvt_pk_bf16_f32 v152, v80, v81
    v_cvt_pk_bf16_f32 v153, v82, v83
    v_cvt_pk_bf16_f32 v154, v84, v85
    v_cvt_pk_bf16_f32 v155, v86, v87
    v_cvt_pk_bf16_f32 v156, v88, v89
    v_cvt_pk_bf16_f32 v157, v90, v91
    v_cvt_pk_bf16_f32 v158, v92, v93
    v_cvt_pk_bf16_f32 v159, v94, v95
    v_permlane32_swap_b32 v152, v154
    v_permlane32_swap_b32 v153, v155
    v_permlane32_swap_b32 v156, v158
    v_permlane32_swap_b32 v157, v159
    buffer_store_dwordx4 v[152:155], v10, s[32:35], s87 offen
    buffer_store_dwordx4 v[156:159], v10, s[32:35], s87 offen offset:32
Lfin:
Lend:
    s_endpgm
Lhelp:
    s_add_u32 m0, s52, 32768
    s_nop 0
    buffer_load_dwordx4 v95, s[4:7], s64 offen  lds
    s_add_u32 s47, s64, s50
    s_add_u32 m0, s51, 32768
    s_nop 0
    buffer_load_dwordx4 v95, s[4:7], s47 offen  lds
    s_add_u32 m0, s52, 40960
    s_nop 0
    buffer_load_dwordx4 v95, s[4:7], s65 offen  lds
    s_add_u32 s47, s65, s50
    s_add_u32 m0, s51, 40960
    s_nop 0
    buffer_load_dwordx4 v95, s[4:7], s47 offen  lds
    s_add_u32 m0, s52, 49152
    s_nop 0
    buffer_load_dwordx4 v95, s[4:7], s66 offen  lds
    s_add_u32 s47, s66, s50
    s_add_u32 m0, s51, 49152
    s_nop 0
    buffer_load_dwordx4 v95, s[4:7], s47 offen  lds
    s_mov_b32 s18, 0x62000
    s_mov_b32 s19, 0x20000
    s_mov_b32 s22, 0x188000
    s_mov_b32 s23, 0x20000
    s_mov_b32 s26, 0x188000
    s_mov_b32 s27, 0x20000
    s_mov_b32 s34, 0x1c0000
    s_mov_b32 s35, 0x20000
    s_and_b32 s87, s79, 1
    s_mul_i32 s87, s87, 3
    s_lshr_b32 s88, s79, 1
    s_add_u32 s87, s87, s88
    s_mul_i32 s88, s87, 37
    s_lshr_b32 s88, s88, 8
    s_mul_i32 s88, s88, 7
    s_sub_u32 s80, s87, s88
    s_add_u32 s81, s80, 1
    s_cmp_eq_u32 s81, 7
    s_cselect_b32 s81, 0, s81
    s_add_u32 s82, s81, 1
    s_cmp_eq_u32 s82, 7
    s_cselect_b32 s82, 0, s82
    s_add_u32 s83, s82, 1
    s_cmp_eq_u32 s83, 7
    s_cselect_b32 s83, 0, s83
    s_add_u32 s84, s83, 1
    s_cmp_eq_u32 s84, 7
    s_cselect_b32 s84, 0, s84
    s_add_u32 s85, s84, 1
    s_cmp_eq_u32 s85, 7
    s_cselect_b32 s85, 0, s85
    s_add_u32 s86, s85, 1
    s_cmp_eq_u32 s86, 7
    s_cselect_b32 s86, 0, s86
    v_bfe_u32 v4, v0, 4, 1
    v_bfe_u32 v5, v0, 1, 1
    v_lshl_add_u32 v5, v4, 1, v5
    v_bfe_u32 v4, v0, 3, 1
    v_xor_b32 v4, s76, v4
    v_lshl_add_u32 v5, v4, 2, v5
    v_lshlrev_b32 v5, 4, v5
    v_and_b32 v4, 1, v0
    v_lshl_add_u32 v5, v4, 3, v5
    v_bfe_u32 v4, v0, 2, 2
    v_lshrrev_b32 v6, 5, v0
    v_lshl_add_u32 v4, v6, 2, v4
    v_lshl_add_u32 v252, v4, 7, v5
    v_xor_b32 v253, 64, v252
    s_mul_i32 s87, s42, 14336
    s_add_u32 s87, s87, 57344
    v_add_u32 v244, s87, v252
    v_add_u32 v245, s87, v253
    v_lshrrev_b32 v4, 3, v0
    v_mul_u32_u24 v4, 3584, v4
    v_bfe_u32 v5, v0, 1, 2
    v_bfe_u32 v6, v0, 4, 1
    v_xor_b32 v5, v5, v6
    v_and_b32 v6, 1, v0
    v_lshl_add_u32 v4, v6, 4, v4
    s_lshl_b32 s87, s77, 7
    v_add_u32 v4, s87, v4
    v_lshl_add_u32 v248, v5, 5, v4
    v_xor_b32 v5, 2, v5
    v_lshl_add_u32 v249, v5, 5, v4
    s_mul_i32 s53, s42, 28672
    s_cmp_lg_u32 s42, 0
    s_cbranch_scc1 Lh23
    s_waitcnt vmcnt(6)
    v_readlane_b32 s87, v192, 0
    v_readlane_b32 s88, v192, 1
    s_nop 3
    s_add_u32 s87, s87, s88
    s_cmp_lt_u32 s87, 256
    s_cselect_b64 vcc, -1, 0
    s_cbranch_vccnz Lini24_slow
Lini24:
    s_lshl_b32 s89, s44, 5
    s_add_u32 s89, s89, s43
    s_lshl_b32 s89, s89, 12
    s_add_u32 s89, s89, 4194304
    s_mov_b32 s59, 0
Lspin25:
    buffer_load_dwordx4 v[200:203], v2, s[36:39], s89 offen offset:0 sc1
    buffer_load_dwordx4 v[204:207], v2, s[36:39], s89 offen offset:1024 sc1
    buffer_load_dwordx4 v[208:211], v2, s[36:39], s89 offen offset:2048 sc1
    buffer_load_dwordx4 v[212:215], v2, s[36:39], s89 offen offset:3072 sc1
    s_waitcnt vmcnt(3)
    v_max3_u32 v4, v200, v201, v202
    s_waitcnt vmcnt(2)
    v_max3_u32 v5, v203, v204, v205
    v_max3_u32 v4, v4, v206, v207
    s_waitcnt vmcnt(1)
    v_max3_u32 v5, v5, v208, v209
    v_max3_u32 v4, v4, v210, v211
    s_waitcnt vmcnt(0)
    v_max3_u32 v5, v5, v212, v213
    v_max3_u32 v4, v4, v214, v215
    v_max_u32 v4, v4, v5
    v_cmp_eq_u32 vcc, -1, v4
    s_nop 3
    s_cbranch_vccnz Lretry27
    s_branch Lout26
Lretry27:
    s_sleep 1
    s_add_u32 s59, s59, 1
    s_cmp_lt_u32 s59, 200000
    s_cbranch_scc1 Lspin25
Lout26:
    v_dot2_f32_bf16 v168, v200, s91, 0
    v_dot2_f32_bf16 v169, v200, s92, 0
    v_dot2_f32_bf16 v170, v201, s91, 0
    v_dot2_f32_bf16 v171, v201, s92, 0
    v_dot2_f32_bf16 v172, v202, s91, 0
    v_dot2_f32_bf16 v173, v202, s92, 0
    v_dot2_f32_bf16 v174, v203, s91, 0
    v_dot2_f32_bf16 v175, v203, s92, 0
    v_dot2_f32_bf16 v168, v204, s91, v168
    v_dot2_f32_bf16 v169, v204, s92, v169
    v_dot2_f32_bf16 v170, v205, s91, v170
    v_dot2_f32_bf16 v171, v205, s92, v171
    v_dot2_f32_bf16 v172, v206, s91, v172
    v_dot2_f32_bf16 v173, v206, s92, v173
    v_dot2_f32_bf16 v174, v207, s91, v174
    v_dot2_f32_bf16 v175, v207, s92, v175
    v_dot2_f32_bf16 v168, v208, s91, v168
    v_dot2_f32_bf16 v169, v208, s92, v169
    v_dot2_f32_bf16 v170, v209, s91, v170
    v_dot2_f32_bf16 v171, v209, s92, v171
    v_dot2_f32_bf16 v172, v210, s91, v172
    v_dot2_f32_bf16 v173, v210, s92, v173
    v_dot2_f32_bf16 v174, v211, s91, v174
    v_dot2_f32_bf16 v175, v211, s92, v175
    v_dot2_f32_bf16 v168, v212, s91, v168
    v_dot2_f32_bf16 v169, v212, s92, v169
    v_dot2_f32_bf16 v170, v213, s91, v170
    v_dot2_f32_bf16 v171, v213, s92, v171
    v_dot2_f32_bf16 v172, v214, s91, v172
    v_dot2_f32_bf16 v173, v214, s92, v173
    v_dot2_f32_bf16 v174, v215, s91, v174
    v_dot2_f32_bf16 v175, v215, s92, v175
    v_add_f32_dpp v168, v168, v168 row_ror:8 row_mask:0xf bank_mask:0xf
    v_add_f32_dpp v169, v169, v169 row_ror:8 row_mask:0xf bank_mask:0xf
    v_add_f32_dpp v170, v170, v170 row_ror:8 row_mask:0xf bank_mask:0xf
    v_add_f32_dpp v171, v171, v171 row_ror:8 row_mask:0xf bank_mask:0xf
    v_add_f32_dpp v172, v172, v172 row_ror:8 row_mask:0xf bank_mask:0xf
    v_add_f32_dpp v173, v173, v173 row_ror:8 row_mask:0xf bank_mask:0xf
    v_add_f32_dpp v174, v174, v174 row_ror:8 row_mask:0xf bank_mask:0xf
    v_add_f32_dpp v175, v175, v175 row_ror:8 row_mask:0xf bank_mask:0xf
    v_mov_b64 v[176:177], v[168:169]
    v_mov_b64 v[178:179], v[170:171]
    v_mov_b64 v[180:181], v[172:173]
    v_mov_b64 v[182:183], v[174:175]
    v_permlane16_swap_b32 v168, v176
    v_permlane16_swap_b32 v169, v177
    v_permlane16_swap_b32 v170, v178
    v_permlane16_swap_b32 v171, v179
    v_permlane16_swap_b32 v172, v180
    v_permlane16_swap_b32 v173, v181
    v_permlane16_swap_b32 v174, v182
    v_permlane16_swap_b32 v175, v183
    v_pk_add_f32 v[168:169], v[168:169], v[176:177]
    v_pk_add_f32 v[170:171], v[170:171], v[178:179]
    v_pk_add_f32 v[172:173], v[172:173], v[180:181]
    v_pk_add_f32 v[174:175], v[174:175], v[182:183]
    v_mov_b64 v[176:177], v[168:169]
    v_mov_b64 v[178:179], v[170:171]
    v_mov_b64 v[180:181], v[172:173]
    v_mov_b64 v[182:183], v[174:175]
    v_permlane32_swap_b32 v168, v176
    v_permlane32_swap_b32 v169, v177
    v_permlane32_swap_b32 v170, v178
    v_permlane32_swap_b32 v171, v179
    v_permlane32_swap_b32 v172, v180
    v_permlane32_swap_b32 v173, v181
    v_permlane32_swap_b32 v174, v182
    v_permlane32_swap_b32 v175, v183
    v_pk_add_f32 v[168:169], v[168:169], v[176:177]
    v_pk_add_f32 v[170:171], v[170:171], v[178:179]
    v_pk_add_f32 v[172:173], v[172:173], v[180:181]
    v_pk_add_f32 v[174:175], v[174:175], v[182:183]
    v_cvt_pk_bf16_f32 v4, v168, v169
    v_cvt_pk_bf16_f32 v5, v170, v171
    v_cvt_pk_bf16_f32 v6, v172, v173
    v_cvt_pk_bf16_f32 v7, v174, v175
    v_min_u32 v4, -2, v4
    v_min_u32 v5, -2, v5
    v_min_u32 v6, -2, v6
    v_min_u32 v7, -2, v7
    s_mov_b64 exec, 0xff
    buffer_store_dwordx4 v[4:7], v2, s[36:39], s97 offen sc1
    s_mov_b64 exec, -1
Lh23:
    s_cmp_ge_u32 s77, 28
    s_cbranch_scc1 Lh28
    s_lshl_b32 s87, s77, 2
    s_add_u32 s87, s87, s42
    s_lshl_b32 s96, s87, 11
    s_add_u32 s96, s96, 17825792
    s_lshl_b32 s87, s42, 11
    v_add_u32 v38, s87, v252
    v_add_u32 v39, s87, v253
    s_lshl_b32 s87, s76, 10
    v_add_u32 v40, s87, v2
    s_xor_b32 s87, s87, 1024
    v_add_u32 v41, s87, v2
    s_waitcnt vmcnt(0)
    ds_read_b64_tr_b16 v[80:81], v38 offset:0
    ds_read_b64_tr_b16 v[82:83], v38 offset:1024
    ds_read_b64_tr_b16 v[84:85], v39 offset:0
    ds_read_b64_tr_b16 v[86:87], v39 offset:1024
    ds_read_b64_tr_b16 v[88:89], v38 offset:8192
    ds_read_b64_tr_b16 v[90:91], v38 offset:9216
    ds_read_b64_tr_b16 v[92:93], v39 offset:8192
    ds_read_b64_tr_b16 v[94:95], v39 offset:9216
    ds_read_b64_tr_b16 v[96:97], v38 offset:16384
    ds_read_b64_tr_b16 v[98:99], v38 offset:17408
    ds_read_b64_tr_b16 v[100:101], v39 offset:16384
    ds_read_b64_tr_b16 v[102:103], v39 offset:17408
    ds_read_b64_tr_b16 v[104:105], v38 offset:24576
    ds_read_b64_tr_b16 v[106:107], v38 offset:25600
    ds_read_b64_tr_b16 v[108:109], v39 offset:24576
    ds_read_b64_tr_b16 v[110:111], v39 offset:25600
    ds_read_b64_tr_b16 v[112:113], v38 offset:32768
    ds_read_b64_tr_b16 v[114:115], v38 offset:33792
    ds_read_b64_tr_b16 v[116:117], v39 offset:32768
    ds_read_b64_tr_b16 v[118:119], v39 offset:33792
    ds_read_b64_tr_b16 v[120:121], v38 offset:40960
    ds_read_b64_tr_b16 v[122:123], v38 offset:41984
    ds_read_b64_tr_b16 v[124:125], v39 offset:40960
    ds_read_b64_tr_b16 v[126:127], v39 offset:41984
    ds_read_b64_tr_b16 v[128:129], v38 offset:49152
    ds_read_b64_tr_b16 v[130:131], v38 offset:50176
    ds_read_b64_tr_b16 v[132:133], v39 offset:49152
    ds_read_b64_tr_b16 v[134:135], v39 offset:50176
    s_waitcnt lgkmcnt(15)
    buffer_store_dwordx4 v[80:83], v40, s[36:39], s96 offen sc1
    buffer_store_dwordx4 v[84:87], v41, s[36:39], s96 offen sc1
    s_add_u32 s96, s96, 229376
    buffer_store_dwordx4 v[88:91], v40, s[36:39], s96 offen sc1
    buffer_store_dwordx4 v[92:95], v41, s[36:39], s96 offen sc1
    s_add_u32 s96, s96, 229376
    buffer_store_dwordx4 v[96:99], v40, s[36:39], s96 offen sc1
    buffer_store_dwordx4 v[100:103], v41, s[36:39], s96 offen sc1
    s_add_u32 s96, s96, 229376
    s_waitcnt lgkmcnt(14)
    buffer_store_dwordx4 v[104:107], v40, s[36:39], s96 offen sc1
    s_waitcnt lgkmcnt(12)
    buffer_store_dwordx4 v[108:111], v41, s[36:39], s96 offen sc1
    s_add_u32 s96, s96, 229376
    s_waitcnt lgkmcnt(10)
    buffer_store_dwordx4 v[112:115], v40, s[36:39], s96 offen sc1
    s_waitcnt lgkmcnt(8)
    buffer_store_dwordx4 v[116:119], v41, s[36:39], s96 offen sc1
    s_add_u32 s96, s96, 229376
    s_waitcnt lgkmcnt(6)
    buffer_store_dwordx4 v[120:123], v40, s[36:39], s96 offen sc1
    s_waitcnt lgkmcnt(4)
    buffer_store_dwordx4 v[124:127], v41, s[36:39], s96 offen sc1
    s_add_u32 s96, s96, 229376
    s_waitcnt lgkmcnt(2)
    buffer_store_dwordx4 v[128:131], v40, s[36:39], s96 offen sc1
    s_waitcnt lgkmcnt(0)
    buffer_store_dwordx4 v[132:135], v41, s[36:39], s96 offen sc1
    s_add_u32 s96, s96, 229376
    s_waitcnt vmcnt(0)
    s_barrier
    s_mul_i32 s46, s77, 37
    s_lshr_b32 s46, s46, 8
    s_lshl_b32 s46, s46, 7
    s_add_u32 s46, s46, 8945664
    s_mov_b32 s45, 1
    s_atomic_add s45, s[36:37], s46
    s_mul_i32 s47, s80, 229376
    s_add_u32 s47, s47, s53
    s_add_u32 s47, s47, 0
    s_add_u32 m0, s57, 49152
    s_nop 0
    buffer_load_dwordx4 v248, s[20:23], s47 offen  lds
    s_mul_i32 s47, s80, 229376
    s_add_u32 s47, s47, s53
    s_add_u32 s47, s47, 0
    s_add_u32 m0, s57, 106496
    s_nop 0
    buffer_load_dwordx4 v249, s[24:27], s47 offen  lds
    s_mul_i32 s47, s80, 229376
    s_add_u32 s47, s47, s53
    s_add_u32 s47, s47, 114688
    s_add_u32 m0, s57, 53248
    s_nop 0
    buffer_load_dwordx4 v248, s[20:23], s47 offen  lds
    s_mul_i32 s47, s80, 229376
    s_add_u32 s47, s47, s53
    s_add_u32 s47, s47, 114688
    s_add_u32 m0, s57, 110592
    s_nop 0
    buffer_load_dwordx4 v249, s[24:27], s47 offen  lds
    s_mul_i32 s47, s81, 229376
    s_add_u32 s47, s47, s53
    s_add_u32 s47, s47, 0
    s_add_u32 m0, s57, 57344
    s_nop 0
    buffer_load_dwordx4 v248, s[20:23], s47 offen  lds
    s_mul_i32 s47, s81, 229376
    s_add_u32 s47, s47, s53
    s_add_u32 s47, s47, 0
    s_add_u32 m0, s57, 114688
    s_nop 0
    buffer_load_dwordx4 v249, s[24:27], s47 offen  lds
    s_mul_i32 s47, s81, 229376
    s_add_u32 s47, s47, s53
    s_add_u32 s47, s47, 114688
    s_add_u32 m0, s57, 61440
    s_nop 0
    buffer_load_dwordx4 v248, s[20:23], s47 offen  lds
    s_mul_i32 s47, s81, 229376
    s_add_u32 s47, s47, s53
    s_add_u32 s47, s47, 114688
    s_add_u32 m0, s57, 118784
    s_nop 0
    buffer_load_dwordx4 v249, s[24:27], s47 offen  lds
    s_mul_i32 s47, s82, 229376
    s_add_u32 s47, s47, s53
    s_add_u32 s47, s47, 0
    s_add_u32 m0, s57, 65536
    s_nop 0
    buffer_load_dwordx4 v248, s[20:23], s47 offen  lds
    s_mul_i32 s47, s82, 229376
    s_add_u32 s47, s47, s53
    s_add_u32 s47, s47, 0
    s_add_u32 m0, s57, 122880
    s_nop 0
    buffer_load_dwordx4 v249, s[24:27], s47 offen  lds
    s_mul_i32 s47, s82, 229376
    s_add_u32 s47, s47, s53
    s_add_u32 s47, s47, 114688
    s_add_u32 m0, s57, 69632
    s_nop 0
    buffer_load_dwordx4 v248, s[20:23], s47 offen  lds
    s_mul_i32 s47, s82, 229376
    s_add_u32 s47, s47, s53
    s_add_u32 s47, s47, 114688
    s_add_u32 m0, s57, 126976
    s_nop 0
    buffer_load_dwordx4 v249, s[24:27], s47 offen  lds
    s_mul_i32 s47, s83, 229376
    s_add_u32 s47, s47, s53
    s_add_u32 s47, s47, 0
    s_add_u32 m0, s57, 73728
    s_nop 0
    buffer_load_dwordx4 v248, s[20:23], s47 offen  lds
    s_mul_i32 s47, s83, 229376
    s_add_u32 s47, s47, s53
    s_add_u32 s47, s47, 0
    s_add_u32 m0, s57, 131072
    s_nop 0
    buffer_load_dwordx4 v249, s[24:27], s47 offen  lds
    s_mul_i32 s47, s83, 229376
    s_add_u32 s47, s47, s53
    s_add_u32 s47, s47, 114688
    s_add_u32 m0, s57, 77824
    s_nop 0
    buffer_load_dwordx4 v248, s[20:23], s47 offen  lds
    s_mul_i32 s47, s83, 229376
    s_add_u32 s47, s47, s53
    s_add_u32 s47, s47, 114688
    s_add_u32 m0, s57, 135168
    s_nop 0
    buffer_load_dwordx4 v249, s[24:27], s47 offen  lds
    s_mul_i32 s47, s84, 229376
    s_add_u32 s47, s47, s53
    s_add_u32 s47, s47, 0
    s_add_u32 m0, s57, 81920
    s_nop 0
    buffer_load_dwordx4 v248, s[20:23], s47 offen  lds
    s_mul_i32 s47, s84, 229376
    s_add_u32 s47, s47, s53
    s_add_u32 s47, s47, 0
    s_add_u32 m0, s57, 139264
    s_nop 0
    buffer_load_dwordx4 v249, s[24:27], s47 offen  lds
    s_mul_i32 s47, s84, 229376
    s_add_u32 s47, s47, s53
    s_add_u32 s47, s47, 114688
    s_add_u32 m0, s57, 86016
    s_nop 0
    buffer_load_dwordx4 v248, s[20:23], s47 offen  lds
    s_mul_i32 s47, s84, 229376
    s_add_u32 s47, s47, s53
    s_add_u32 s47, s47, 114688
    s_add_u32 m0, s57, 143360
    s_nop 0
    buffer_load_dwordx4 v249, s[24:27], s47 offen  lds
    s_mul_i32 s47, s85, 229376
    s_add_u32 s47, s47, s53
    s_add_u32 s47, s47, 0
    s_add_u32 m0, s57, 90112
    s_nop 0
    buffer_load_dwordx4 v248, s[20:23], s47 offen  lds
    s_mul_i32 s47, s85, 229376
    s_add_u32 s47, s47, s53
    s_add_u32 s47, s47, 0
    s_add_u32 m0, s57, 147456
    s_nop 0
    buffer_load_dwordx4 v249, s[24:27], s47 offen  lds
    s_mul_i32 s47, s85, 229376
    s_add_u32 s47, s47, s53
    s_add_u32 s47, s47, 114688
    s_add_u32 m0, s57, 94208
    s_nop 0
    buffer_load_dwordx4 v248, s[20:23], s47 offen  lds
    s_mul_i32 s47, s85, 229376
    s_add_u32 s47, s47, s53
    s_add_u32 s47, s47, 114688
    s_add_u32 m0, s57, 151552
    s_nop 0
    buffer_load_dwordx4 v249, s[24:27], s47 offen  lds
    s_mul_i32 s47, s86, 229376
    s_add_u32 s47, s47, s53
    s_add_u32 s47, s47, 0
    s_add_u32 m0, s57, 98304
    s_nop 0
    buffer_load_dwordx4 v248, s[20:23], s47 offen  lds
    s_mul_i32 s47, s86, 229376
    s_add_u32 s47, s47, s53
    s_add_u32 s47, s47, 0
    s_add_u32 m0, s57, 155648
    s_nop 0
    buffer_load_dwordx4 v249, s[24:27], s47 offen  lds
    s_mul_i32 s47, s86, 229376
    s_add_u32 s47, s47, s53
    s_add_u32 s47, s47, 114688
    s_add_u32 m0, s57, 102400
    s_nop 0
    buffer_load_dwordx4 v248, s[20:23], s47 offen  lds
    s_mul_i32 s47, s86, 229376
    s_add_u32 s47, s47, s53
    s_add_u32 s47, s47, 114688
    s_add_u32 m0, s57, 159744
    s_nop 0
    buffer_load_dwordx4 v249, s[24:27], s47 offen  lds
    v_bfe_u32 v40, v0, 2, 2
    v_lshrrev_b32 v41, 5, v0
    v_lshl_add_u32 v40, v41, 2, v40
    v_lshlrev_b32 v40, 7, v40
    v_bfe_u32 v41, v0, 4, 1
    v_mul_u32_u24 v42, 57344, v41
    v_add_u32 v40, v40, v42
    v_and_b32 v42, 3, v0
    v_lshl_add_u32 v40, v42, 3, v40
    v_add_u32 v40, 49152, v40
    v_lshlrev_b32 v41, 1, v41
    v_bfe_u32 v42, v0, 3, 1
    v_add_u32 v41, v41, v42
    v_xor_b32 v42, s42, v41
    v_lshl_add_u32 v3, v42, 5, v40
    v_mov_b32 v4, 0
    v_mov_b32 v5, 0
    v_mov_b32 v6, 0
    v_mov_b32 v7, 0
    s_waitcnt vmcnt(0)
    s_barrier
    ds_read_b64_tr_b16 v[80:81], v3 offset:0
    ds_read_b64_tr_b16 v[82:83], v3 offset:1024
    ds_read_b64_tr_b16 v[84:85], v3 offset:2048
    ds_read_b64_tr_b16 v[86:87], v3 offset:3072
    ds_read_b64_tr_b16 v[88:89], v3 offset:4096
    ds_read_b64_tr_b16 v[90:91], v3 offset:5120
    ds_read_b64_tr_b16 v[92:93], v3 offset:6144
    ds_read_b64_tr_b16 v[94:95], v3 offset:7168
    ds_read_b64_tr_b16 v[96:97], v3 offset:8192
    ds_read_b64_tr_b16 v[98:99], v3 offset:9216
    ds_read_b64_tr_b16 v[100:101], v3 offset:10240
    ds_read_b64_tr_b16 v[102:103], v3 offset:11264
    ds_read_b64_tr_b16 v[104:105], v3 offset:12288
    ds_read_b64_tr_b16 v[106:107], v3 offset:13312
    s_waitcnt lgkmcnt(13)
    v_dot2c_f32_bf16 v4, s68, v80
    v_dot2c_f32_bf16 v5, s68, v81
    s_waitcnt lgkmcnt(12)
    v_dot2c_f32_bf16 v6, s68, v82
    v_dot2c_f32_bf16 v7, s68, v83
    s_waitcnt lgkmcnt(11)
    v_dot2c_f32_bf16 v4, s68, v84
    v_dot2c_f32_bf16 v5, s68, v85
    s_waitcnt lgkmcnt(10)
    v_dot2c_f32_bf16 v6, s68, v86
    v_dot2c_f32_bf16 v7, s68, v87
    s_waitcnt lgkmcnt(9)
    v_dot2c_f32_bf16 v4, s68, v88
    v_dot2c_f32_bf16 v5, s68, v89
    s_waitcnt lgkmcnt(8)
    v_dot2c_f32_bf16 v6, s68, v90
    v_dot2c_f32_bf16 v7, s68, v91
    s_waitcnt lgkmcnt(7)
    v_dot2c_f32_bf16 v4, s68, v92
    v_dot2c_f32_bf16 v5, s68, v93
    s_waitcnt lgkmcnt(6)
    v_dot2c_f32_bf16 v6, s68, v94
    v_dot2c_f32_bf16 v7, s68, v95
    s_waitcnt lgkmcnt(5)
    v_dot2c_f32_bf16 v4, s68, v96
    v_dot2c_f32_bf16 v5, s68, v97
    s_waitcnt lgkmcnt(4)
    v_dot2c_f32_bf16 v6, s68, v98
    v_dot2c_f32_bf16 v7, s68, v99
    s_waitcnt lgkmcnt(3)
    v_dot2c_f32_bf16 v4, s68, v100
    v_dot2c_f32_bf16 v5, s68, v101
    s_waitcnt lgkmcnt(2)
    v_dot2c_f32_bf16 v6, s68, v102
    v_dot2c_f32_bf16 v7, s68, v103
    s_waitcnt lgkmcnt(1)
    v_dot2c_f32_bf16 v4, s68, v104
    v_dot2c_f32_bf16 v5, s68, v105
    s_waitcnt lgkmcnt(0)
    v_dot2c_f32_bf16 v6, s68, v106
    v_dot2c_f32_bf16 v7, s68, v107
    ds_read_b64_tr_b16 v[80:81], v3 offset:14336
    ds_read_b64_tr_b16 v[82:83], v3 offset:15360
    ds_read_b64_tr_b16 v[84:85], v3 offset:16384
    ds_read_b64_tr_b16 v[86:87], v3 offset:17408
    ds_read_b64_tr_b16 v[88:89], v3 offset:18432
    ds_read_b64_tr_b16 v[90:91], v3 offset:19456
    ds_read_b64_tr_b16 v[92:93], v3 offset:20480
    ds_read_b64_tr_b16 v[94:95], v3 offset:21504
    ds_read_b64_tr_b16 v[96:97], v3 offset:22528
    ds_read_b64_tr_b16 v[98:99], v3 offset:23552
    ds_read_b64_tr_b16 v[100:101], v3 offset:24576
    ds_read_b64_tr_b16 v[102:103], v3 offset:25600
    ds_read_b64_tr_b16 v[104:105], v3 offset:26624
    ds_read_b64_tr_b16 v[106:107], v3 offset:27648
    s_waitcnt lgkmcnt(13)
    v_dot2c_f32_bf16 v4, s68, v80
    v_dot2c_f32_bf16 v5, s68, v81
    s_waitcnt lgkmcnt(12)
    v_dot2c_f32_bf16 v6, s68, v82
    v_dot2c_f32_bf16 v7, s68, v83
    s_waitcnt lgkmcnt(11)
    v_dot2c_f32_bf16 v4, s68, v84
    v_dot2c_f32_bf16 v5, s68, v85
    s_waitcnt lgkmcnt(10)
    v_dot2c_f32_bf16 v6, s68, v86
    v_dot2c_f32_bf16 v7, s68, v87
    s_waitcnt lgkmcnt(9)
    v_dot2c_f32_bf16 v4, s68, v88
    v_dot2c_f32_bf16 v5, s68, v89
    s_waitcnt lgkmcnt(8)
    v_dot2c_f32_bf16 v6, s68, v90
    v_dot2c_f32_bf16 v7, s68, v91
    s_waitcnt lgkmcnt(7)
    v_dot2c_f32_bf16 v4, s68, v92
    v_dot2c_f32_bf16 v5, s68, v93
    s_waitcnt lgkmcnt(6)
    v_dot2c_f32_bf16 v6, s68, v94
    v_dot2c_f32_bf16 v7, s68, v95
    s_waitcnt lgkmcnt(5)
    v_dot2c_f32_bf16 v4, s68, v96
    v_dot2c_f32_bf16 v5, s68, v97
    s_waitcnt lgkmcnt(4)
    v_dot2c_f32_bf16 v6, s68, v98
    v_dot2c_f32_bf16 v7, s68, v99
    s_waitcnt lgkmcnt(3)
    v_dot2c_f32_bf16 v4, s68, v100
    v_dot2c_f32_bf16 v5, s68, v101
    s_waitcnt lgkmcnt(2)
    v_dot2c_f32_bf16 v6, s68, v102
    v_dot2c_f32_bf16 v7, s68, v103
    s_waitcnt lgkmcnt(1)
    v_dot2c_f32_bf16 v4, s68, v104
    v_dot2c_f32_bf16 v5, s68, v105
    s_waitcnt lgkmcnt(0)
    v_dot2c_f32_bf16 v6, s68, v106
    v_dot2c_f32_bf16 v7, s68, v107
    ds_read_b64_tr_b16 v[80:81], v3 offset:28672
    ds_read_b64_tr_b16 v[82:83], v3 offset:29696
    ds_read_b64_tr_b16 v[84:85], v3 offset:30720
    ds_read_b64_tr_b16 v[86:87], v3 offset:31744
    ds_read_b64_tr_b16 v[88:89], v3 offset:32768
    ds_read_b64_tr_b16 v[90:91], v3 offset:33792
    ds_read_b64_tr_b16 v[92:93], v3 offset:34816
    ds_read_b64_tr_b16 v[94:95], v3 offset:35840
    ds_read_b64_tr_b16 v[96:97], v3 offset:36864
    ds_read_b64_tr_b16 v[98:99], v3 offset:37888
    ds_read_b64_tr_b16 v[100:101], v3 offset:38912
    ds_read_b64_tr_b16 v[102:103], v3 offset:39936
    ds_read_b64_tr_b16 v[104:105], v3 offset:40960
    ds_read_b64_tr_b16 v[106:107], v3 offset:41984
    s_waitcnt lgkmcnt(13)
    v_dot2c_f32_bf16 v4, s68, v80
    v_dot2c_f32_bf16 v5, s68, v81
    s_waitcnt lgkmcnt(12)
    v_dot2c_f32_bf16 v6, s68, v82
    v_dot2c_f32_bf16 v7, s68, v83
    s_waitcnt lgkmcnt(11)
    v_dot2c_f32_bf16 v4, s68, v84
    v_dot2c_f32_bf16 v5, s68, v85
    s_waitcnt lgkmcnt(10)
    v_dot2c_f32_bf16 v6, s68, v86
    v_dot2c_f32_bf16 v7, s68, v87
    s_waitcnt lgkmcnt(9)
    v_dot2c_f32_bf16 v4, s68, v88
    v_dot2c_f32_bf16 v5, s68, v89
    s_waitcnt lgkmcnt(8)
    v_dot2c_f32_bf16 v6, s68, v90
    v_dot2c_f32_bf16 v7, s68, v91
    s_waitcnt lgkmcnt(7)
    v_dot2c_f32_bf16 v4, s68, v92
    v_dot2c_f32_bf16 v5, s68, v93
    s_waitcnt lgkmcnt(6)
    v_dot2c_f32_bf16 v6, s68, v94
    v_dot2c_f32_bf16 v7, s68, v95
    s_waitcnt lgkmcnt(5)
    v_dot2c_f32_bf16 v4, s68, v96
    v_dot2c_f32_bf16 v5, s68, v97
    s_waitcnt lgkmcnt(4)
    v_dot2c_f32_bf16 v6, s68, v98
    v_dot2c_f32_bf16 v7, s68, v99
    s_waitcnt lgkmcnt(3)
    v_dot2c_f32_bf16 v4, s68, v100
    v_dot2c_f32_bf16 v5, s68, v101
    s_waitcnt lgkmcnt(2)
    v_dot2c_f32_bf16 v6, s68, v102
    v_dot2c_f32_bf16 v7, s68, v103
    s_waitcnt lgkmcnt(1)
    v_dot2c_f32_bf16 v4, s68, v104
    v_dot2c_f32_bf16 v5, s68, v105
    s_waitcnt lgkmcnt(0)
    v_dot2c_f32_bf16 v6, s68, v106
    v_dot2c_f32_bf16 v7, s68, v107
    ds_read_b64_tr_b16 v[80:81], v3 offset:43008
    ds_read_b64_tr_b16 v[82:83], v3 offset:44032
    ds_read_b64_tr_b16 v[84:85], v3 offset:45056
    ds_read_b64_tr_b16 v[86:87], v3 offset:46080
    ds_read_b64_tr_b16 v[88:89], v3 offset:47104
    ds_read_b64_tr_b16 v[90:91], v3 offset:48128
    ds_read_b64_tr_b16 v[92:93], v3 offset:49152
    ds_read_b64_tr_b16 v[94:95], v3 offset:50176
    ds_read_b64_tr_b16 v[96:97], v3 offset:51200
    ds_read_b64_tr_b16 v[98:99], v3 offset:52224
    ds_read_b64_tr_b16 v[100:101], v3 offset:53248
    ds_read_b64_tr_b16 v[102:103], v3 offset:54272
    ds_read_b64_tr_b16 v[104:105], v3 offset:55296
    ds_read_b64_tr_b16 v[106:107], v3 offset:56320
    s_waitcnt lgkmcnt(13)
    v_dot2c_f32_bf16 v4, s68, v80
    v_dot2c_f32_bf16 v5, s68, v81
    s_waitcnt lgkmcnt(12)
    v_dot2c_f32_bf16 v6, s68, v82
    v_dot2c_f32_bf16 v7, s68, v83
    s_waitcnt lgkmcnt(11)
    v_dot2c_f32_bf16 v4, s68, v84
    v_dot2c_f32_bf16 v5, s68, v85
    s_waitcnt lgkmcnt(10)
    v_dot2c_f32_bf16 v6, s68, v86
    v_dot2c_f32_bf16 v7, s68, v87
    s_waitcnt lgkmcnt(9)
    v_dot2c_f32_bf16 v4, s68, v88
    v_dot2c_f32_bf16 v5, s68, v89
    s_waitcnt lgkmcnt(8)
    v_dot2c_f32_bf16 v6, s68, v90
    v_dot2c_f32_bf16 v7, s68, v91
    s_waitcnt lgkmcnt(7)
    v_dot2c_f32_bf16 v4, s68, v92
    v_dot2c_f32_bf16 v5, s68, v93
    s_waitcnt lgkmcnt(6)
    v_dot2c_f32_bf16 v6, s68, v94
    v_dot2c_f32_bf16 v7, s68, v95
    s_waitcnt lgkmcnt(5)
    v_dot2c_f32_bf16 v4, s68, v96
    v_dot2c_f32_bf16 v5, s68, v97
    s_waitcnt lgkmcnt(4)
    v_dot2c_f32_bf16 v6, s68, v98
    v_dot2c_f32_bf16 v7, s68, v99
    s_waitcnt lgkmcnt(3)
    v_dot2c_f32_bf16 v4, s68, v100
    v_dot2c_f32_bf16 v5, s68, v101
    s_waitcnt lgkmcnt(2)
    v_dot2c_f32_bf16 v6, s68, v102
    v_dot2c_f32_bf16 v7, s68, v103
    s_waitcnt lgkmcnt(1)
    v_dot2c_f32_bf16 v4, s68, v104
    v_dot2c_f32_bf16 v5, s68, v105
    s_waitcnt lgkmcnt(0)
    v_dot2c_f32_bf16 v6, s68, v106
    v_dot2c_f32_bf16 v7, s68, v107
    v_add_f32 v4, v4, v5
    s_nop 1
    v_add_f32 v6, v6, v7
    v_add_f32 v4, v4, v6
    v_mov_b32 v5, v4
    s_nop 1
    v_permlane32_swap_b32 v4, v5
    v_add_f32 v4, v4, v5
    v_cvt_pk_bf16_f32 v5, v4, v4
    v_and_b32 v6, s69, v5
    v_sub_f32 v6, v4, v6
    v_cvt_pk_bf16_f32 v6, v6, v6
    v_cmp_gt_u32 vcc, 32, v0
    v_and_b32 v7, 0xffff, v5
    v_and_or_b32 v6, v6, s69, v7
    v_min_u32 v6, -2, v6
    v_cndmask_b32 v6, 0, v6, vcc
    v_cndmask_b32 v7, 0, v7, vcc
    buffer_store_dwordx2 v[6:7], v2, s[36:39], s3 offen sc1
Lh28:
    s_branch Lfin
Lini8_slow:
    s_mov_b32 s59, 0
Lspin29:
    v_lshlrev_b32 v4, 5, v0
    s_mov_b32 s89, 9240576
    v_lshlrev_b32 v4, 7, v0
    s_mov_b64 exec, 3
    global_load_dword v192, v4, s[40:41] sc1
    s_mov_b64 exec, -1
    s_waitcnt vmcnt(0)
    v_readlane_b32 s87, v192, 0
    v_readlane_b32 s88, v192, 1
    s_nop 3
    s_add_u32 s87, s87, s88
    s_cmp_lt_u32 s87, 256
    s_cselect_b64 vcc, -1, 0
    s_cbranch_vccnz Lretry31
    s_branch Lout30
Lretry31:
    s_sleep 1
    s_add_u32 s59, s59, 1
    s_cmp_lt_u32 s59, 200000
    s_cbranch_scc1 Lspin29
Lout30:
    s_nop 7
    s_nop 3
    s_branch Lini8
Lri11_slow:
    s_waitcnt vmcnt(0)
    s_mov_b32 s93, 1
    s_lshl_b32 s73, s43, 10
    s_add_u32 s73, s73, 8912896
    s_mov_b32 s45, 1
    s_atomic_add s45, s[36:37], s73
    s_mov_b32 s59, 0
Lspin32:
    buffer_load_dwordx4 v[200:203], v2, s[36:39], s89 offen offset:0 sc1
    buffer_load_dwordx4 v[204:207], v2, s[36:39], s89 offen offset:1024 sc1
    buffer_load_dwordx4 v[208:211], v2, s[36:39], s89 offen offset:2048 sc1
    buffer_load_dwordx4 v[212:215], v2, s[36:39], s89 offen offset:3072 sc1
    s_waitcnt vmcnt(3)
    v_max3_u32 v4, v200, v201, v202
    s_waitcnt vmcnt(2)
    v_max3_u32 v5, v203, v204, v205
    v_max3_u32 v4, v4, v206, v207
    s_waitcnt vmcnt(1)
    v_max3_u32 v5, v5, v208, v209
    v_max3_u32 v4, v4, v210, v211
    s_waitcnt vmcnt(0)
    v_max3_u32 v5, v5, v212, v213
    v_max3_u32 v4, v4, v214, v215
    v_max_u32 v4, v4, v5
    v_cmp_eq_u32 vcc, -1, v4
    s_nop 3
    s_cbranch_vccnz Lretry34
    s_branch Lout33
Lretry34:
    s_sleep 1
    s_add_u32 s59, s59, 1
    s_cmp_lt_u32 s59, 200000
    s_cbranch_scc1 Lspin32
Lout33:
    s_branch Lri11
Lsc13_slow:
    s_mov_b32 s59, 0
Lspin35:
    s_load_dword s72, s[36:37], s73 glc
    s_waitcnt lgkmcnt(0)
    s_cmp_lt_u32 s72, 28
    s_cbranch_scc1 Lretry37
    s_branch Lout36
Lretry37:
    s_sleep 1
    s_add_u32 s59, s59, 1
    s_cmp_lt_u32 s59, 200000
    s_cbranch_scc1 Lspin35
Lout36:
    s_branch Lsc13
Lkvslow:
    s_mov_b32 s59, 0
Lspin38:
    s_lshl_b32 s46, s42, 13
    s_add_u32 s46, s46, 8388608
    s_add_u32 s47, s46, 4096
    buffer_load_dwordx4 v[200:203], v2, s[36:39], s46 offen offset:0 sc1
    buffer_load_dwordx4 v[204:207], v2, s[36:39], s46 offen offset:1024 sc1
    buffer_load_dwordx4 v[208:211], v2, s[36:39], s46 offen offset:2048 sc1
    buffer_load_dwordx4 v[212:215], v2, s[36:39], s46 offen offset:3072 sc1
    buffer_load_dwordx4 v[216:219], v2, s[36:39], s47 offen offset:0 sc1
    buffer_load_dwordx4 v[220:223], v2, s[36:39], s47 offen offset:1024 sc1
    buffer_load_dwordx4 v[224:227], v2, s[36:39], s47 offen offset:2048 sc1
    buffer_load_dwordx4 v[228:231], v2, s[36:39], s47 offen offset:3072 sc1
    s_waitcnt vmcnt(7)
    v_max3_u32 v4, v200, v201, v202
    s_waitcnt vmcnt(6)
    v_max3_u32 v5, v203, v204, v205
    v_max3_u32 v4, v4, v206, v207
    s_waitcnt vmcnt(5)
    v_max3_u32 v5, v5, v208, v209
    v_max3_u32 v4, v4, v210, v211
    s_waitcnt vmcnt(4)
    v_max3_u32 v5, v5, v212, v213
    v_max3_u32 v4, v4, v214, v215
    s_waitcnt vmcnt(3)
    v_max3_u32 v5, v5, v216, v217
    v_max3_u32 v4, v4, v218, v219
    s_waitcnt vmcnt(2)
    v_max3_u32 v5, v5, v220, v221
    v_max3_u32 v4, v4, v222, v223
    s_waitcnt vmcnt(1)
    v_max3_u32 v5, v5, v224, v225
    v_max3_u32 v4, v4, v226, v227
    s_waitcnt vmcnt(0)
    v_max3_u32 v5, v5, v228, v229
    v_max3_u32 v4, v4, v230, v231
    v_max_u32 v4, v4, v5
    v_cmp_eq_u32 vcc, -1, v4
    s_nop 3
    s_cbranch_vccnz Lretry40
    s_branch Lout39
Lretry40:
    s_sleep 1
    s_add_u32 s59, s59, 1
    s_cmp_lt_u32 s59, 200000
    s_cbranch_scc1 Lspin38
Lout39:
    s_branch Lkvok
Lwf14_slow:
    s_mov_b32 s59, 0
Lspin41:
    s_mov_b64 exec, 1
    buffer_load_dword v1, v2, s[36:39], s73 offen sc1
    s_mov_b64 exec, -1
    s_waitcnt vmcnt(0)
    v_cmp_gt_u32 vcc, 28, v1
    s_nop 3
    s_cbranch_vccnz Lretry43
    s_branch Lout42
Lretry43:
    s_sleep 1
    s_add_u32 s59, s59, 1
    s_cmp_lt_u32 s59, 200000
    s_cbranch_scc1 Lspin41
Lout42:
    s_branch Lwf14
Lcsslow:
    s_mov_b32 s59, 0
Lspin44:
    buffer_load_dwordx4 v[24:27], v2, s[36:39], s3 offen offset:0 sc1
    buffer_load_dwordx4 v[28:31], v2, s[36:39], s3 offen offset:1024 sc1
    s_waitcnt vmcnt(1)
    v_max3_u32 v4, v24, v25, v26
    s_waitcnt vmcnt(0)
    v_max3_u32 v5, v27, v28, v29
    v_max3_u32 v4, v4, v30, v31
    v_max_u32 v4, v4, v5
    v_cmp_eq_u32 vcc, -1, v4
    s_nop 3
    s_cbranch_vccnz Lretry46
    s_branch Lout45
Lretry46:
    s_sleep 1
    s_add_u32 s59, s59, 1
    s_cmp_lt_u32 s59, 200000
    s_cbranch_scc1 Lspin44
Lout45:
    s_branch Lcsok
Lstslow:
    s_add_u32 s59, s59, 1
    s_cmp_lt_u32 s59, 200000
    s_cbranch_scc1 Lp3b17
    s_branch Lstok
Lsc21_slow:
    s_mov_b32 s59, 0
Lspin47:
    s_load_dword s72, s[36:37], s73 glc
    s_waitcnt lgkmcnt(0)
    s_cmp_lt_u32 s72, 7
    s_cbranch_scc1 Lretry49
    s_branch Lout48
Lretry49:
    s_sleep 1
    s_add_u32 s59, s59, 1
    s_cmp_lt_u32 s59, 200000
    s_cbranch_scc1 Lspin47
Lout48:
    s_branch Lsc21
Lsc22_slow:
    s_mov_b32 s59, 0
Lspin50:
    s_load_dword s72, s[36:37], s73 glc
    s_waitcnt lgkmcnt(0)
    s_cmp_lt_u32 s72, 7
    s_cbranch_scc1 Lretry52
    s_branch Lout51
Lretry52:
    s_sleep 1
    s_add_u32 s59, s59, 1
    s_cmp_lt_u32 s59, 200000
    s_cbranch_scc1 Lspin50
Lout51:
    s_branch Lsc22
Lini24_slow:
    s_mov_b32 s59, 0
Lspin53:
    v_lshlrev_b32 v4, 5, v0
    s_mov_b32 s89, 9240576
    v_lshlrev_b32 v4, 7, v0
    s_mov_b64 exec, 3
    global_load_dword v192, v4, s[40:41] sc1
    s_mov_b64 exec, -1
    s_waitcnt vmcnt(0)
    v_readlane_b32 s87, v192, 0
    v_readlane_b32 s88, v192, 1
    s_nop 3
    s_add_u32 s87, s87, s88
    s_cmp_lt_u32 s87, 256
    s_cselect_b64 vcc, -1, 0
    s_cbranch_vccnz Lretry55
    s_branch Lout54
Lretry55:
    s_sleep 1
    s_add_u32 s59, s59, 1
    s_cmp_lt_u32 s59, 200000
    s_cbranch_scc1 Lspin53
Lout54:
    s_nop 7
    s_nop 3
    s_branch Lini24
Lslow:
    s_waitcnt vmcnt(0) lgkmcnt(0)
    s_mov_b32 s93, 1
    s_mov_b32 s87, 0
Lsl56:
    s_add_u32 s88, s89, s87
    s_mov_b32 s59, 0
Lspin57:
    buffer_load_dwordx4 v[56:59], v2, s[36:39], s88 offen sc1
    s_waitcnt vmcnt(0)
    v_max3_u32 v56, v56, v57, v58
    v_max_u32 v56, v56, v59
    v_cmp_eq_u32 vcc, -1, v56
    s_nop 3
    s_cbranch_vccnz Lretry59
    s_branch Lout58
Lretry59:
    s_sleep 1
    s_add_u32 s59, s59, 1
    s_cmp_lt_u32 s59, 200000
    s_cbranch_scc1 Lspin57
Lout58:
    s_add_u32 s87, s87, 1024
    s_cmp_lt_u32 s87, 57344
    s_cbranch_scc1 Lsl56
    s_nop 7
    s_nop 7
    s_branch Lp315
Lcode_end:
    s_endpgm

.section .rodata,"a"
.p2align 6
.amdhsa_kernel sequential_preLN__linear_attn_block__glu_gated_glu__prompt_kernel
  .amdhsa_next_free_vgpr 512
  .amdhsa_next_free_sgpr 102
  .amdhsa_accum_offset 256
  .amdhsa_group_segment_fixed_size 0
  .amdhsa_kernarg_size 80
  .amdhsa_user_sgpr_count 2
  .amdhsa_user_sgpr_kernarg_segment_ptr 1
  .amdhsa_system_sgpr_workgroup_id_x 1
  .amdhsa_float_denorm_mode_32 3
.end_amdhsa_kernel
```
